```python
import torch

def _softmax(x, axis=-1):
    return torch.softmax(x, dim=axis)
def _gelu(x):
    return torch.nn.functional.gelu(x, approximate="tanh")
def _silu(x):
    return torch.nn.functional.silu(x)
def _sigmoid(x):
    return torch.sigmoid(x)
def _layernorm(x, axis=-1, eps=1e-5):
    m = x.mean(dim=axis, keepdim=True)
    v = x.var(dim=axis, keepdim=True, unbiased=False)
    return (x - m) / torch.sqrt(v + eps)
def _scatter_add(tgt, idx, src, axis=0):
    return tgt.clone().index_add_(axis, idx, src)
def _segment_sum(src, seg, n):
    out = torch.zeros((n,) + src.shape[1:], dtype=src.dtype)
    return out.index_add_(0, seg, src)
def _pad(x, pw):
    flat = tuple(v for pair in reversed(pw) for v in pair)
    return torch.nn.functional.pad(x, flat)

kernel_name = 'standalone__sliding_block_cached__sampling'

def setup_inputs():

    _w = (lambda a: (lambda t: t.to(torch.bfloat16) if t.is_floating_point() else t)(torch.as_tensor(a)))
    B, Sq, D = 8, 16, 576
    Hq, Hkv, Sk, Dh = 32, 16, 8192, 128
    assert Hq % Hkv == 0, (Hq, Hkv)
    return {
        "x": _w((lambda *s: torch.randn(*s, dtype=torch.bfloat16) * 0.8)(B, Sq, D)),
        "k_cache": _w((lambda *s: torch.randn(*s, dtype=torch.bfloat16) * 0.8)(B, Hkv, Sk, Dh)),
        "v_cache": _w((lambda *s: torch.randn(*s, dtype=torch.bfloat16) * 0.05)(B, Hkv, Sk, Dh)),
        "wq": _w((lambda *s: torch.randn(*s, dtype=torch.bfloat16) * 0.8)(D, Hq * Dh) * (D ** -0.5)),
        "wo": _w((lambda *s: torch.randn(*s, dtype=torch.bfloat16) * 0.05)(Hq * Dh, D) * ((Hq * Dh) ** -0.5)),
    }

def reference(x, k_cache, v_cache, wq, wo):
    B, Sq, D = x.shape
    Hq, Dh = 32, 128
    Hkv, Sk = k_cache.shape[1], k_cache.shape[2]
    W = min(4096, max(256, Sk // 4))
    rep = Hq // Hkv
    q = (lambda x, *d: x.permute(*d))((x @ wq).reshape(B, Sq, Hq, Dh), 0, 2, 1, 3)
    k = (lambda x, n, axis: torch.repeat_interleave(x, n, dim=axis))(k_cache[:, :, Sk - W:, :], rep, axis=1)
    v = (lambda x, n, axis: torch.repeat_interleave(x, n, dim=axis))(v_cache[:, :, Sk - W:, :], rep, axis=1)
    scores = torch.einsum("bhqd,bhkd->bhqk", q, k) * (Dh ** -0.5)
    p = _softmax(scores, axis=-1)
    o = torch.einsum("bhqk,bhkd->bhqd", p, v)
    return (lambda x, *d: x.permute(*d))(o, 0, 2, 1, 3).reshape(B, Sq, Hq * Dh) @ wo
```

```asm
; @launch grid=(256,1,1) block=(256,1,1) lds=163840
.amdgcn_target "amdgcn-amd-amdhsa--gfx950"
.text
.globl standalone__sliding_block_cached__sampling_kernel
.p2align 8
.type standalone__sliding_block_cached__sampling_kernel,@function
standalone__sliding_block_cached__sampling_kernel:
    s_cmp_ge_u32 s2, 256
    s_cbranch_scc1 L_end
    s_load_dwordx8 s[4:11], s[0:1], 0
    s_load_dwordx8 s[12:19], s[0:1], 32
    s_getpc_b64 s[100:101]
L_pc:
    s_and_b32 s84, s2, 0xf8
    v_add_lshl_u32 v16, v0, s84, 7
    v_min_u32 v16, L_codeend-L_pc-4, v16
    v_cmp_gt_u32 vcc, 8, v0
    s_nop 0
    s_and_saveexec_b64 s[56:57], vcc
    s_cbranch_execz L_nocpf
    global_load_dword a255, v16, s[100:101]
L_nocpf:
    s_mov_b64 exec, s[56:57]
    v_lshrrev_b32 v1, 6, v0
    v_mov_b32 v18, v0
    v_readfirstlane_b32 s3, v1
    v_and_b32 v0, 63, v0
    s_and_b32 s52, s2, 7
    s_lshr_b32 s85, s2, 3
    s_and_b32 s83, s85, 1
    s_lshl_b32 s61, s52, 1
    s_add_u32 s63, s61, s83
    s_lshr_b32 s64, s85, 1
    s_and_b32 s64, s64, 1
    s_lshr_b32 s65, s85, 2
    v_lshrrev_b32 v20, 4, v0
    v_and_b32 v21, 15, v0
    v_lshlrev_b32 v10, 4, v0
    v_lshlrev_b32 v22, 2, v20
    v_xor_b32 v22, v21, v22
    v_lshlrev_b32 v22, 4, v22
    v_lshl_add_u32 v2, v20, 8, v22
    v_xor_b32 v3, 16, v2
    v_xor_b32 v4, 32, v2
    v_xor_b32 v5, 48, v2
    s_mul_i32 s62, s3, 32768
    s_lshl_b32 s76, s65, 4
    s_add_u32 s76, s76, s63
    s_lshl_b32 s83, s76, 21
    s_add_u32 s83, s83, 1572864
    s_lshl_b32 s84, s64, 18
    s_add_u32 s83, s83, s84
    s_lshl_b32 s84, s3, 16
    s_add_u32 s83, s83, s84
    s_lshl_b32 s76, s76, 1
    s_add_u32 s76, s76, s64
    v_mov_b32 v23, 0x7ffffff0
    v_cmp_gt_u32 vcc, 144, v18
    v_lshrrev_b32 v22, 3, v18
    s_mul_i32 s84, s85, 18
    v_add_u32 v22, s84, v22
    v_lshlrev_b32 v22, 13, v22
    v_and_b32 v24, 7, v18
    v_lshl_add_u32 v22, v24, 7, v22
    v_cndmask_b32 v16, v23, v22, vcc
    v_lshlrev_b32 v22, 7, v18
    v_cndmask_b32 v17, v23, v22, vcc
    s_waitcnt lgkmcnt(0)
    s_add_u32 s20, s6, s83
    s_addc_u32 s21, s7, 0
    s_mov_b32 s22, 65536
    s_mov_b32 s23, 0x20000
    s_mov_b32 s68, s10
    s_mov_b32 s69, s11
    s_mov_b32 s70, 4718592
    s_mov_b32 s71, 0x20000
    s_lshl_b32 s84, s52, 10
    buffer_load_dword a255, v16, s[68:71], s84 offen
    s_add_u32 s24, s8, s83
    s_addc_u32 s25, s9, 0
    s_mov_b32 s26, 65536
    s_mov_b32 s27, 0x20000
    s_mul_i32 s83, s65, 18432
    s_add_u32 s36, s4, s83
    s_addc_u32 s37, s5, 0
    s_mov_b32 s38, 18432
    s_mov_b32 s39, 0x20000
    s_lshl_b32 s84, s3, 10
    s_add_u32 m0, s84, 131072
    s_add_u32 s61, s84, 0
    buffer_load_dwordx4 v10, s[36:39], s61 offen lds
    s_add_u32 m0, s84, 135168
    s_add_u32 s61, s84, 4096
    buffer_load_dwordx4 v10, s[36:39], s61 offen lds
    s_add_u32 m0, s84, 139264
    s_add_u32 s61, s84, 8192
    buffer_load_dwordx4 v10, s[36:39], s61 offen lds
    s_add_u32 m0, s84, 143360
    s_add_u32 s61, s84, 12288
    buffer_load_dwordx4 v10, s[36:39], s61 offen lds
    s_add_u32 m0, s84, 147456
    s_add_u32 s61, s84, 16384
    buffer_load_dwordx4 v10, s[36:39], s61 offen lds
    s_lshl_b32 s84, s65, 8
    s_add_u32 s84, s84, 12
    s_load_dword s66, s[18:19], s84
    v_accvgpr_write_b32 a254, v17
    s_mov_b64 exec, 1
    s_cmp_eq_u32 s3, 0
    s_cbranch_scc0 L_tl1
    v_mov_b32 v16, 0
    buffer_load_dword a255, v16, s[20:23], 0 offen nt
    buffer_load_dword a255, v16, s[24:27], 0 offen nt
L_tl1:
    s_cmp_eq_u32 s3, 1
    s_cbranch_scc0 L_tl2
    s_lshl_b32 s83, s76, 14
    s_add_u32 s83, s83, 1048576
    v_mov_b32 v16, s83
    global_load_dword a255, v16, s[18:19]
    s_lshl_b32 s83, s65, 1
    s_add_u32 s83, s83, s64
    s_mul_i32 s83, s83, 196608
    s_mul_i32 s84, s63, 768
    s_add_u32 s83, s83, s84
    s_add_u32 s83, s83, 8388608
    v_mov_b32 v16, s83
    global_load_dword a255, v16, s[18:19]
    s_lshl_b32 s83, s76, 9
    s_add_u32 s83, s83, 65536
    v_mov_b32 v16, s83
    global_load_dword a255, v16, s[18:19]
L_tl2:
    s_cmp_eq_u32 s3, 2
    s_cbranch_scc0 L_tl3
    s_mul_i32 s83, s63, 294912
    v_mov_b32 v16, s83
    global_load_dword a255, v16, s[12:13]
    s_add_u32 s83, s83, 293760
    v_mov_b32 v16, s83
    global_load_dword a255, v16, s[12:13]
    s_mul_i32 s83, s76, 576
    v_mov_b32 v16, s83
    global_load_dword a255, v16, s[14:15]
L_tl3:
    s_mov_b64 exec, -1
    s_and_b32 s83, s3, 1
    s_lshl_b32 s84, s63, 1
    s_add_u32 s83, s83, s84
    s_lshl_b32 s83, s83, 8
    s_lshr_b32 s84, s3, 1
    s_mul_i32 s61, s84, 2359296
    s_add_u32 s83, s83, s61
    s_add_u32 s28, s10, s83
    s_addc_u32 s29, s11, 0
    s_mov_b32 s30, 2351360
    s_mov_b32 s31, 0x20000
    v_lshlrev_b32 v22, 4, v21
    v_lshl_add_u32 v11, v20, 16, v22
    s_mul_i32 s84, s84, 576
    s_add_u32 s84, s84, 131072
    v_mul_u32_u24 v22, 1152, v21
    v_lshl_add_u32 v22, v20, 4, v22
    v_add_u32 v12, s84, v22
    s_mov_b32 s48, 0x05040100
    s_mov_b32 s49, 0x07060302
    s_getreg_b32 s80, hwreg(HW_REG_XCC_ID, 0, 4)
    s_mov_b32 s81, 1
    s_mov_b32 s44, s14
    s_mov_b32 s45, s15
    s_mov_b32 s46, 147456
    s_mov_b32 s47, 0x20000
    s_mov_b32 s68, s12
    s_mov_b32 s69, s13
    s_mov_b32 s70, 4718592
    s_mov_b32 s71, 0x20000
    s_mul_i32 s83, s63, 294912
    s_mul_i32 s84, s64, 576
    s_add_u32 s83, s83, s84
    s_mul_i32 s84, s3, 192
    s_add_u32 s83, s83, s84
    s_add_u32 s32, s12, s83
    s_addc_u32 s33, s13, 0
    s_mov_b32 s34, 293952
    s_mov_b32 s35, 0x20000
    s_mov_b32 s40, s18
    s_mov_b32 s41, s19
    s_mov_b32 s42, 16777216
    s_mov_b32 s43, 0x20000
    s_cmp_eq_u32 s3, 3
    s_cselect_b32 s34, 0, s34
    s_mov_b32 s50, 0x3e0293ee
    v_lshrrev_b32 v176, 4, v0
    v_and_b32 v177, 15, v0
    v_mul_u32_u24 v178, 4608, v176
    v_mul_u32_u24 v179, 12, v177
    v_add_u32 v13, v178, v179
    v_and_b32 v178, 3, v177
    v_lshlrev_b32 v178, 2, v178
    v_lshrrev_b32 v179, 2, v177
    v_add_u32 v178, v178, v179
    v_lshlrev_b32 v179, 2, v176
    v_xor_b32 v179, v179, v178
    v_lshlrev_b32 v179, 4, v179
    v_lshl_add_u32 v179, v177, 8, v179
    v_add_u32 v6, s62, v179
    v_xor_b32 v7, 16, v6
    v_xor_b32 v8, 32, v6
    v_xor_b32 v9, 48, v6
    v_mov_b32 v14, 0xff800000
    v_mov_b32 v15, 0xff800000
    s_mov_b32 s79, 0
    s_add_u32 s53, s62, 0
    s_add_u32 s55, s62, 8192
    s_cmp_eq_u32 s64, 0
    s_cbranch_scc1 L_QB
    s_mov_b32 s61, 0
    s_add_u32 m0, s62, 0
    s_nop 0
    buffer_load_dwordx4 v2, s[20:23], s61 offen offset:0 nt lds
    buffer_load_dwordx4 v3, s[20:23], s61 offen offset:1024 nt lds
    s_waitcnt vmcnt(7)
    buffer_load_dwordx4 v4, s[20:23], s61 offen offset:2048 nt lds
    s_waitcnt vmcnt(7)
    buffer_load_dwordx4 v5, s[20:23], s61 offen offset:3072 nt lds
    s_waitcnt vmcnt(7)
    s_mov_b32 s61, 4096
    s_add_u32 m0, s62, 4096
    s_nop 0
    buffer_load_dwordx4 v2, s[20:23], s61 offen offset:0 nt lds
    s_waitcnt vmcnt(7)
    buffer_load_dwordx4 v3, s[20:23], s61 offen offset:1024 nt lds
    s_waitcnt vmcnt(7)
    buffer_load_dwordx4 v4, s[20:23], s61 offen offset:2048 nt lds
    s_waitcnt vmcnt(7)
    buffer_load_dwordx4 v5, s[20:23], s61 offen offset:3072 nt lds
    s_waitcnt vmcnt(7)
    s_mov_b32 s61, 8192
    s_add_u32 m0, s62, 8192
    s_nop 0
    buffer_load_dwordx4 v2, s[20:23], s61 offen offset:0 nt lds
    s_waitcnt vmcnt(7)
    buffer_load_dwordx4 v3, s[20:23], s61 offen offset:1024 nt lds
    s_waitcnt vmcnt(7)
    buffer_load_dwordx4 v4, s[20:23], s61 offen offset:2048 nt lds
    s_waitcnt vmcnt(7)
    buffer_load_dwordx4 v5, s[20:23], s61 offen offset:3072 nt lds
    s_waitcnt vmcnt(7)
    s_mov_b32 s61, 12288
    s_add_u32 m0, s62, 12288
    s_nop 0
    buffer_load_dwordx4 v2, s[20:23], s61 offen offset:0 nt lds
    s_waitcnt vmcnt(7)
    buffer_load_dwordx4 v3, s[20:23], s61 offen offset:1024 nt lds
    s_waitcnt vmcnt(7)
    buffer_load_dwordx4 v4, s[20:23], s61 offen offset:2048 nt lds
    s_waitcnt vmcnt(7)
    buffer_load_dwordx4 v5, s[20:23], s61 offen offset:3072 nt lds
L_QB_ret0:
    s_lshl_b32 s83, s76, 14
    s_lshl_b32 s84, s3, 12
    s_add_u32 s83, s83, s84
    s_add_u32 s83, s83, 1048576
    v_lshl_add_u32 v176, v0, 7, s83
    s_mul_i32 s83, s3, 24
    s_sub_u32 s83, s83, 24
    v_add_u32 v177, s83, v0
    v_mul_u32_u24 v178, 10923, v177
    v_lshrrev_b32 v178, 16, v178
    v_mul_u32_u24 v178, 11520, v178
    v_lshl_add_u32 v178, v177, 7, v178
    s_lshl_b32 s83, s65, 1
    s_add_u32 s83, s83, s64
    s_mul_i32 s83, s83, 196608
    s_mul_i32 s84, s63, 768
    s_add_u32 s83, s83, s84
    s_add_u32 s83, s83, 8388608
    v_add_u32 v178, s83, v178
    v_cmp_gt_u32 vcc, 24, v0
    v_mov_b32 v179, 0x7ffffff0
    s_nop 0
    v_cndmask_b32 v176, v178, v176, vcc
    v_cmp_gt_u32 vcc, 24, v0
    s_nop 1
    v_cndmask_b32 v176, v179, v176, vcc
    buffer_load_dword a255, v176, s[40:43], 0 offen
    s_waitcnt vmcnt(7)
    s_mov_b32 s61, 16384
    s_add_u32 m0, s62, 16384
    s_nop 0
    buffer_load_dwordx4 v2, s[20:23], s61 offen offset:0 nt lds
    ds_read_b128 a[0:3], v6 offset:0
    s_waitcnt vmcnt(7)
    buffer_load_dwordx4 v3, s[20:23], s61 offen offset:1024 nt lds
    ds_read_b128 a[4:7], v7 offset:0
    s_waitcnt vmcnt(7)
    buffer_load_dwordx4 v4, s[20:23], s61 offen offset:2048 nt lds
    ds_read_b128 a[8:11], v8 offset:0
    s_waitcnt vmcnt(7)
    buffer_load_dwordx4 v5, s[20:23], s61 offen offset:3072 nt lds
    ds_read_b128 a[12:15], v9 offset:0
    s_waitcnt vmcnt(7)
    s_mov_b32 s61, 20480
    s_add_u32 m0, s62, 20480
    s_nop 0
    buffer_load_dwordx4 v2, s[20:23], s61 offen offset:0 nt lds
    ds_read_b128 a[16:19], v6 offset:4096
    s_waitcnt vmcnt(7)
    buffer_load_dwordx4 v3, s[20:23], s61 offen offset:1024 nt lds
    ds_read_b128 a[20:23], v7 offset:4096
    s_waitcnt vmcnt(7)
    buffer_load_dwordx4 v4, s[20:23], s61 offen offset:2048 nt lds
    ds_read_b128 a[24:27], v8 offset:4096
    s_waitcnt vmcnt(7)
    buffer_load_dwordx4 v5, s[20:23], s61 offen offset:3072 nt lds
    ds_read_b128 a[28:31], v9 offset:4096
    v_accvgpr_read_b32 v1, a254
    s_lshl_b32 s84, s52, 5
    s_add_u32 s84, s84, s85
    s_mul_i32 s84, s84, 18432
    buffer_load_dword a255, v1, s[68:71], s84 offen
    s_mul_i32 s84, s76, 576
    s_lshl_b32 s83, s3, 13
    s_add_u32 s84, s84, s83
    v_lshlrev_b32 v177, 7, v0
    v_cmp_gt_u32 vcc, 5, v0
    v_mov_b32 v178, 0x7ffffff0
    s_cmp_eq_u32 s3, 0
    s_cselect_b64 vcc, vcc, 0
    v_cndmask_b32 v177, v178, v177, vcc
    buffer_load_dword a255, v177, s[44:47], s84 offen
    s_waitcnt vmcnt(7)
    s_mov_b32 s61, 24576
    s_add_u32 m0, s62, 24576
    s_nop 0
    buffer_load_dwordx4 v2, s[20:23], s61 offen offset:0 nt lds
    ds_read_b128 a[32:35], v6 offset:8192
    s_waitcnt vmcnt(7)
    buffer_load_dwordx4 v3, s[20:23], s61 offen offset:1024 nt lds
    ds_read_b128 a[36:39], v7 offset:8192
    s_waitcnt vmcnt(7)
    buffer_load_dwordx4 v4, s[20:23], s61 offen offset:2048 nt lds
    ds_read_b128 a[40:43], v8 offset:8192
    s_waitcnt vmcnt(7)
    buffer_load_dwordx4 v5, s[20:23], s61 offen offset:3072 nt lds
    ds_read_b128 a[44:47], v9 offset:8192
    s_waitcnt vmcnt(7)
    s_mov_b32 s61, 28672
    s_add_u32 m0, s62, 28672
    s_nop 0
    buffer_load_dwordx4 v2, s[20:23], s61 offen offset:0 nt lds
    ds_read_b128 a[48:51], v6 offset:12288
    s_waitcnt vmcnt(7)
    buffer_load_dwordx4 v3, s[20:23], s61 offen offset:1024 nt lds
    ds_read_b128 a[52:55], v7 offset:12288
    s_waitcnt vmcnt(7)
    buffer_load_dwordx4 v4, s[20:23], s61 offen offset:2048 nt lds
    ds_read_b128 a[56:59], v8 offset:12288
    s_waitcnt vmcnt(7)
    buffer_load_dwordx4 v5, s[20:23], s61 offen offset:3072 nt lds
    ds_read_b128 a[60:63], v9 offset:12288
    s_waitcnt lgkmcnt(0)
    s_waitcnt lgkmcnt(0)
    s_mov_b32 s79, 32768
    s_add_u32 s53, s62, 0
    s_add_u32 s55, s62, 8192
    s_cmp_eq_u32 s64, 1
    s_cbranch_scc1 L_QB
    s_waitcnt vmcnt(7)
    s_mov_b32 s61, 32768
    s_add_u32 m0, s62, 0
    s_nop 0
    buffer_load_dwordx4 v2, s[20:23], s61 offen offset:0 nt lds
    s_waitcnt vmcnt(7)
    buffer_load_dwordx4 v3, s[20:23], s61 offen offset:1024 nt lds
    s_waitcnt vmcnt(7)
    buffer_load_dwordx4 v4, s[20:23], s61 offen offset:2048 nt lds
    s_waitcnt vmcnt(7)
    buffer_load_dwordx4 v5, s[20:23], s61 offen offset:3072 nt lds
    s_waitcnt vmcnt(7)
    s_mov_b32 s61, 36864
    s_add_u32 m0, s62, 4096
    s_nop 0
    buffer_load_dwordx4 v2, s[20:23], s61 offen offset:0 nt lds
    s_waitcnt vmcnt(7)
    buffer_load_dwordx4 v3, s[20:23], s61 offen offset:1024 nt lds
    s_waitcnt vmcnt(7)
    buffer_load_dwordx4 v4, s[20:23], s61 offen offset:2048 nt lds
    s_waitcnt vmcnt(7)
    buffer_load_dwordx4 v5, s[20:23], s61 offen offset:3072 nt lds
    s_waitcnt vmcnt(7)
    s_mov_b32 s61, 40960
    s_add_u32 m0, s62, 8192
    s_nop 0
    buffer_load_dwordx4 v2, s[20:23], s61 offen offset:0 nt lds
    s_waitcnt vmcnt(7)
    buffer_load_dwordx4 v3, s[20:23], s61 offen offset:1024 nt lds
    s_waitcnt vmcnt(7)
    buffer_load_dwordx4 v4, s[20:23], s61 offen offset:2048 nt lds
    s_waitcnt vmcnt(7)
    buffer_load_dwordx4 v5, s[20:23], s61 offen offset:3072 nt lds
    s_waitcnt vmcnt(7)
    s_mov_b32 s61, 45056
    s_add_u32 m0, s62, 12288
    s_nop 0
    buffer_load_dwordx4 v2, s[20:23], s61 offen offset:0 nt lds
    s_waitcnt vmcnt(7)
    buffer_load_dwordx4 v3, s[20:23], s61 offen offset:1024 nt lds
    s_waitcnt vmcnt(7)
    buffer_load_dwordx4 v4, s[20:23], s61 offen offset:2048 nt lds
    s_waitcnt vmcnt(7)
    buffer_load_dwordx4 v5, s[20:23], s61 offen offset:3072 nt lds
L_QB_ret1:
    s_add_u32 s66, s66, 1
    s_lshl_b32 s9, s52, 7
    s_add_u32 s9, s9, 32768
    s_lshl_b32 s10, s66, 4
    s_mov_b32 s72, s40
    s_mov_b32 s73, s41
    s_mov_b32 s75, 0x20000
    s_cmp_eq_u32 s3, 0
    s_cselect_b32 s74, 16777216, 0
    s_lshl_b32 s83, s85, 2
    v_mov_b32 v176, 0x7ffffff0
    v_lshlrev_b32 v177, 2, v0
    v_cmp_gt_u32 vcc, 32, v0
    s_nop 1
    v_cndmask_b32 v253, v176, v177, vcc
    v_mov_b32 v177, s83
    v_cmp_eq_u32 vcc, 0, v0
    s_nop 1
    v_cndmask_b32 v255, v176, v177, vcc
    s_add_u32 s11, s10, 5
    v_mov_b32 v254, s11
    buffer_store_dword v254, v255, s[72:75], s9 offen
    buffer_load_dword v252, v253, s[40:43], s9 offen nt
    ds_read_b128 a[64:67], v6 offset:16384
    ds_read_b128 a[68:71], v7 offset:16384
    ds_read_b128 a[72:75], v8 offset:16384
    ds_read_b128 a[76:79], v9 offset:16384
    ds_read_b128 a[80:83], v6 offset:20480
    ds_read_b128 a[84:87], v7 offset:20480
    ds_read_b128 a[88:91], v8 offset:20480
    ds_read_b128 a[92:95], v9 offset:20480
    s_waitcnt lgkmcnt(0)
    s_waitcnt vmcnt(17)
    s_cmp_eq_u32 s81, 0
    s_cbranch_scc1 L_t1
    s_waitcnt vmcnt(6)
L_t1:
    s_mov_b32 s61, 49152
    s_add_u32 m0, s62, 16384
    s_nop 0
    buffer_load_dwordx4 v2, s[20:23], s61 offen offset:0 nt lds
    ds_read_b128 a[96:99], v6 offset:24576
    ds_read_b128 a[100:103], v7 offset:24576
    ds_read_b128 a[104:107], v8 offset:24576
    ds_read_b128 a[108:111], v9 offset:24576
    ds_read_b128 a[112:115], v6 offset:28672
    ds_read_b128 a[116:119], v7 offset:28672
    ds_read_b128 a[120:123], v8 offset:28672
    ds_read_b128 a[124:127], v9 offset:28672
    s_waitcnt vmcnt(11)
    ds_read_b128 a[128:131], v6 offset:0
    ds_read_b128 a[132:135], v7 offset:0
    ds_read_b128 a[136:139], v8 offset:0
    ds_read_b128 a[140:143], v9 offset:0
    ds_read_b128 a[144:147], v6 offset:4096
    ds_read_b128 a[148:151], v7 offset:4096
    ds_read_b128 a[152:155], v8 offset:4096
    ds_read_b128 a[156:159], v9 offset:4096
    v_mfma_f32_16x16x32_bf16 v[48:51], a[0:3], v[16:19], 0
    v_mfma_f32_16x16x32_bf16 v[56:59], a[0:3], v[32:35], 0
    v_mfma_f32_16x16x32_bf16 v[52:55], a[16:19], v[16:19], 0
    v_mfma_f32_16x16x32_bf16 v[60:63], a[16:19], v[32:35], 0
    v_mfma_f32_16x16x32_bf16 v[48:51], a[4:7], v[20:23], v[48:51]
    v_mfma_f32_16x16x32_bf16 v[56:59], a[4:7], v[36:39], v[56:59]
    s_cmp_eq_u32 s81, 0
    s_cbranch_scc1 L_t2
    s_waitcnt vmcnt(6)
L_t2:
    buffer_load_dwordx4 v3, s[20:23], s61 offen offset:1024 nt lds
    v_mfma_f32_16x16x32_bf16 v[52:55], a[20:23], v[20:23], v[52:55]
    v_mfma_f32_16x16x32_bf16 v[60:63], a[20:23], v[36:39], v[60:63]
    v_mfma_f32_16x16x32_bf16 v[48:51], a[8:11], v[24:27], v[48:51]
    v_mfma_f32_16x16x32_bf16 v[56:59], a[8:11], v[40:43], v[56:59]
    v_mfma_f32_16x16x32_bf16 v[52:55], a[24:27], v[24:27], v[52:55]
    v_mfma_f32_16x16x32_bf16 v[60:63], a[24:27], v[40:43], v[60:63]
    v_mfma_f32_16x16x32_bf16 v[48:51], a[12:15], v[28:31], v[48:51]
    s_cmp_eq_u32 s81, 0
    s_cbranch_scc1 L_t3
    s_waitcnt vmcnt(6)
L_t3:
    buffer_load_dwordx4 v4, s[20:23], s61 offen offset:2048 nt lds
    v_mfma_f32_16x16x32_bf16 v[56:59], a[12:15], v[44:47], v[56:59]
    v_mfma_f32_16x16x32_bf16 v[52:55], a[28:31], v[28:31], v[52:55]
    v_mfma_f32_16x16x32_bf16 v[60:63], a[28:31], v[44:47], v[60:63]
    v_mfma_f32_16x16x32_bf16 v[64:67], a[32:35], v[16:19], 0
    v_mfma_f32_16x16x32_bf16 v[72:75], a[32:35], v[32:35], 0
    v_mfma_f32_16x16x32_bf16 v[68:71], a[48:51], v[16:19], 0
    s_cmp_eq_u32 s81, 0
    s_cbranch_scc1 L_t4
    s_waitcnt vmcnt(6)
L_t4:
    buffer_load_dwordx4 v5, s[20:23], s61 offen offset:3072 nt lds
    v_mfma_f32_16x16x32_bf16 v[76:79], a[48:51], v[32:35], 0
    v_mfma_f32_16x16x32_bf16 v[64:67], a[36:39], v[20:23], v[64:67]
    v_mfma_f32_16x16x32_bf16 v[72:75], a[36:39], v[36:39], v[72:75]
    v_mfma_f32_16x16x32_bf16 v[68:71], a[52:55], v[20:23], v[68:71]
    v_mfma_f32_16x16x32_bf16 v[76:79], a[52:55], v[36:39], v[76:79]
    v_mfma_f32_16x16x32_bf16 v[64:67], a[40:43], v[24:27], v[64:67]
    v_mfma_f32_16x16x32_bf16 v[72:75], a[40:43], v[40:43], v[72:75]
    s_cmp_eq_u32 s81, 0
    s_cbranch_scc1 L_t5
    s_waitcnt vmcnt(6)
L_t5:
    s_mov_b32 s61, 53248
    s_add_u32 m0, s62, 20480
    s_nop 0
    buffer_load_dwordx4 v2, s[20:23], s61 offen offset:0 nt lds
    v_mfma_f32_16x16x32_bf16 v[68:71], a[56:59], v[24:27], v[68:71]
    v_mfma_f32_16x16x32_bf16 v[76:79], a[56:59], v[40:43], v[76:79]
    v_mfma_f32_16x16x32_bf16 v[64:67], a[44:47], v[28:31], v[64:67]
    v_mfma_f32_16x16x32_bf16 v[72:75], a[44:47], v[44:47], v[72:75]
    v_mfma_f32_16x16x32_bf16 v[68:71], a[60:63], v[28:31], v[68:71]
    v_mfma_f32_16x16x32_bf16 v[76:79], a[60:63], v[44:47], v[76:79]
    v_max3_f32 v14, v14, v48, v49
    v_max3_f32 v15, v15, v56, v57
    v_max3_f32 v14, v14, v50, v51
    s_cmp_eq_u32 s81, 0
    s_cbranch_scc1 L_t6
    s_waitcnt vmcnt(4)
L_t6:
    buffer_load_dwordx4 v3, s[20:23], s61 offen offset:1024 nt lds
    v_max3_f32 v15, v15, v58, v59
    v_max3_f32 v14, v14, v52, v53
    v_max3_f32 v15, v15, v60, v61
    v_max3_f32 v14, v14, v54, v55
    v_max3_f32 v15, v15, v62, v63
    v_mfma_f32_16x16x32_bf16 v[80:83], a[64:67], v[16:19], 0
    v_mfma_f32_16x16x32_bf16 v[88:91], a[64:67], v[32:35], 0
    v_mfma_f32_16x16x32_bf16 v[84:87], a[80:83], v[16:19], 0
    v_mfma_f32_16x16x32_bf16 v[92:95], a[80:83], v[32:35], 0
    v_mfma_f32_16x16x32_bf16 v[80:83], a[68:71], v[20:23], v[80:83]
    s_waitcnt vmcnt(6)
    s_add_u32 s11, s10, 5
    v_subrev_u32 v252, s11, v252
    v_cmp_gt_u32 s[12:13], 11, v252
    s_nop 0
    s_bcnt1_i32_b64 s11, s[12:13]
    s_cmp_le_u32 s11, 0
    s_cselect_b32 s81, 2, 1
    s_cmp_ge_u32 s11, 26
    s_cselect_b32 s81, 0, s81
    s_cmp_eq_u32 s81, 0
    s_cbranch_scc1 L_t7
    s_waitcnt vmcnt(4)
L_t7:
    buffer_load_dwordx4 v4, s[20:23], s61 offen offset:2048 nt lds
    v_mfma_f32_16x16x32_bf16 v[88:91], a[68:71], v[36:39], v[88:91]
    v_mfma_f32_16x16x32_bf16 v[84:87], a[84:87], v[20:23], v[84:87]
    v_mfma_f32_16x16x32_bf16 v[92:95], a[84:87], v[36:39], v[92:95]
    v_mfma_f32_16x16x32_bf16 v[80:83], a[72:75], v[24:27], v[80:83]
    v_mfma_f32_16x16x32_bf16 v[88:91], a[72:75], v[40:43], v[88:91]
    v_mfma_f32_16x16x32_bf16 v[84:87], a[88:91], v[24:27], v[84:87]
    v_mfma_f32_16x16x32_bf16 v[92:95], a[88:91], v[40:43], v[92:95]
    s_cmp_eq_u32 s81, 0
    s_cbranch_scc1 L_t8
    s_waitcnt vmcnt(4)
L_t8:
    buffer_load_dwordx4 v5, s[20:23], s61 offen offset:3072 nt lds
    v_mfma_f32_16x16x32_bf16 v[80:83], a[76:79], v[28:31], v[80:83]
    v_mfma_f32_16x16x32_bf16 v[88:91], a[76:79], v[44:47], v[88:91]
    v_mfma_f32_16x16x32_bf16 v[84:87], a[92:95], v[28:31], v[84:87]
    v_mfma_f32_16x16x32_bf16 v[92:95], a[92:95], v[44:47], v[92:95]
    v_max3_f32 v14, v14, v64, v65
    v_max3_f32 v15, v15, v72, v73
    v_max3_f32 v14, v14, v66, v67
    v_max3_f32 v15, v15, v74, v75
    v_max3_f32 v14, v14, v68, v69
    v_max3_f32 v15, v15, v76, v77
    v_max3_f32 v14, v14, v70, v71
    v_max3_f32 v15, v15, v78, v79
    s_add_u32 s11, s10, 6
    v_mov_b32 v254, s11
    buffer_store_dword v254, v255, s[72:75], s9 offen
    buffer_load_dword v252, v253, s[40:43], s9 offen nt
    s_waitcnt lgkmcnt(8)
    s_cmp_eq_u32 s81, 0
    s_cbranch_scc1 L_t9
    s_waitcnt vmcnt(6)
L_t9:
    s_mov_b32 s61, 57344
    s_add_u32 m0, s62, 24576
    s_nop 0
    buffer_load_dwordx4 v2, s[20:23], s61 offen offset:0 nt lds
    ds_read_b128 a[160:163], v6 offset:8192
    ds_read_b128 a[164:167], v7 offset:8192
    ds_read_b128 a[168:171], v8 offset:8192
    ds_read_b128 a[172:175], v9 offset:8192
    ds_read_b128 a[176:179], v6 offset:12288
    ds_read_b128 a[180:183], v7 offset:12288
    ds_read_b128 a[184:187], v8 offset:12288
    ds_read_b128 a[188:191], v9 offset:12288
    v_mfma_f32_16x16x32_bf16 v[96:99], a[96:99], v[16:19], 0
    v_mfma_f32_16x16x32_bf16 v[104:107], a[96:99], v[32:35], 0
    v_mfma_f32_16x16x32_bf16 v[100:103], a[112:115], v[16:19], 0
    v_mfma_f32_16x16x32_bf16 v[108:111], a[112:115], v[32:35], 0
    v_mfma_f32_16x16x32_bf16 v[96:99], a[100:103], v[20:23], v[96:99]
    v_mfma_f32_16x16x32_bf16 v[104:107], a[100:103], v[36:39], v[104:107]
    v_mfma_f32_16x16x32_bf16 v[100:103], a[116:119], v[20:23], v[100:103]
    v_mfma_f32_16x16x32_bf16 v[108:111], a[116:119], v[36:39], v[108:111]
    v_mfma_f32_16x16x32_bf16 v[96:99], a[104:107], v[24:27], v[96:99]
    v_mfma_f32_16x16x32_bf16 v[104:107], a[104:107], v[40:43], v[104:107]
    s_cmp_eq_u32 s81, 0
    s_cbranch_scc1 L_t10
    s_waitcnt vmcnt(6)
L_t10:
    buffer_load_dwordx4 v3, s[20:23], s61 offen offset:1024 nt lds
    v_mfma_f32_16x16x32_bf16 v[100:103], a[120:123], v[24:27], v[100:103]
    v_mfma_f32_16x16x32_bf16 v[108:111], a[120:123], v[40:43], v[108:111]
    v_mfma_f32_16x16x32_bf16 v[96:99], a[108:111], v[28:31], v[96:99]
    v_mfma_f32_16x16x32_bf16 v[104:107], a[108:111], v[44:47], v[104:107]
    v_mfma_f32_16x16x32_bf16 v[100:103], a[124:127], v[28:31], v[100:103]
    v_mfma_f32_16x16x32_bf16 v[108:111], a[124:127], v[44:47], v[108:111]
    v_max3_f32 v14, v14, v80, v81
    v_max3_f32 v15, v15, v88, v89
    v_max3_f32 v14, v14, v82, v83
    v_max3_f32 v15, v15, v90, v91
    v_max3_f32 v14, v14, v84, v85
    v_max3_f32 v15, v15, v92, v93
    v_max3_f32 v14, v14, v86, v87
    v_max3_f32 v15, v15, v94, v95
    s_waitcnt lgkmcnt(8)
    v_mfma_f32_16x16x32_bf16 v[112:115], a[128:131], v[16:19], 0
    s_cmp_eq_u32 s81, 0
    s_cbranch_scc1 L_t11
    s_waitcnt vmcnt(6)
L_t11:
    buffer_load_dwordx4 v4, s[20:23], s61 offen offset:2048 nt lds
    v_mfma_f32_16x16x32_bf16 v[120:123], a[128:131], v[32:35], 0
    v_mfma_f32_16x16x32_bf16 v[116:119], a[144:147], v[16:19], 0
    v_mfma_f32_16x16x32_bf16 v[124:127], a[144:147], v[32:35], 0
    v_mfma_f32_16x16x32_bf16 v[112:115], a[132:135], v[20:23], v[112:115]
    v_mfma_f32_16x16x32_bf16 v[120:123], a[132:135], v[36:39], v[120:123]
    v_mfma_f32_16x16x32_bf16 v[116:119], a[148:151], v[20:23], v[116:119]
    v_mfma_f32_16x16x32_bf16 v[124:127], a[148:151], v[36:39], v[124:127]
    v_mfma_f32_16x16x32_bf16 v[112:115], a[136:139], v[24:27], v[112:115]
    v_mfma_f32_16x16x32_bf16 v[120:123], a[136:139], v[40:43], v[120:123]
    v_mfma_f32_16x16x32_bf16 v[116:119], a[152:155], v[24:27], v[116:119]
    s_cmp_eq_u32 s81, 0
    s_cbranch_scc1 L_t12
    s_waitcnt vmcnt(6)
L_t12:
    buffer_load_dwordx4 v5, s[20:23], s61 offen offset:3072 nt lds
    v_mfma_f32_16x16x32_bf16 v[124:127], a[152:155], v[40:43], v[124:127]
    v_mfma_f32_16x16x32_bf16 v[112:115], a[140:143], v[28:31], v[112:115]
    v_mfma_f32_16x16x32_bf16 v[120:123], a[140:143], v[44:47], v[120:123]
    v_mfma_f32_16x16x32_bf16 v[116:119], a[156:159], v[28:31], v[116:119]
    v_mfma_f32_16x16x32_bf16 v[124:127], a[156:159], v[44:47], v[124:127]
    v_max3_f32 v14, v14, v96, v97
    v_max3_f32 v15, v15, v104, v105
    v_max3_f32 v14, v14, v98, v99
    v_max3_f32 v15, v15, v106, v107
    v_max3_f32 v14, v14, v100, v101
    v_max3_f32 v15, v15, v108, v109
    v_max3_f32 v14, v14, v102, v103
    v_max3_f32 v15, v15, v110, v111
    s_waitcnt lgkmcnt(0)
    v_mfma_f32_16x16x32_bf16 v[128:131], a[160:163], v[16:19], 0
    v_mfma_f32_16x16x32_bf16 v[136:139], a[160:163], v[32:35], 0
    s_cmp_eq_u32 s81, 0
    s_cbranch_scc1 L_t13
    s_waitcnt vmcnt(6)
L_t13:
    s_mov_b32 s61, 61440
    s_add_u32 m0, s62, 28672
    s_nop 0
    buffer_load_dwordx4 v2, s[20:23], s61 offen offset:0 nt lds
    v_mfma_f32_16x16x32_bf16 v[132:135], a[176:179], v[16:19], 0
    v_mfma_f32_16x16x32_bf16 v[140:143], a[176:179], v[32:35], 0
    v_mfma_f32_16x16x32_bf16 v[128:131], a[164:167], v[20:23], v[128:131]
    v_mfma_f32_16x16x32_bf16 v[136:139], a[164:167], v[36:39], v[136:139]
    v_mfma_f32_16x16x32_bf16 v[132:135], a[180:183], v[20:23], v[132:135]
    v_mfma_f32_16x16x32_bf16 v[140:143], a[180:183], v[36:39], v[140:143]
    v_mfma_f32_16x16x32_bf16 v[128:131], a[168:171], v[24:27], v[128:131]
    v_mfma_f32_16x16x32_bf16 v[136:139], a[168:171], v[40:43], v[136:139]
    v_mfma_f32_16x16x32_bf16 v[132:135], a[184:187], v[24:27], v[132:135]
    v_mfma_f32_16x16x32_bf16 v[140:143], a[184:187], v[40:43], v[140:143]
    s_cmp_eq_u32 s81, 0
    s_cbranch_scc1 L_t14
    s_waitcnt vmcnt(4)
L_t14:
    buffer_load_dwordx4 v3, s[20:23], s61 offen offset:1024 nt lds
    v_mfma_f32_16x16x32_bf16 v[128:131], a[172:175], v[28:31], v[128:131]
    v_mfma_f32_16x16x32_bf16 v[136:139], a[172:175], v[44:47], v[136:139]
    v_mfma_f32_16x16x32_bf16 v[132:135], a[188:191], v[28:31], v[132:135]
    v_mfma_f32_16x16x32_bf16 v[140:143], a[188:191], v[44:47], v[140:143]
    v_max3_f32 v14, v14, v112, v113
    v_max3_f32 v15, v15, v120, v121
    v_max3_f32 v14, v14, v114, v115
    v_max3_f32 v15, v15, v122, v123
    v_max3_f32 v14, v14, v116, v117
    v_max3_f32 v15, v15, v124, v125
    v_max3_f32 v14, v14, v118, v119
    v_max3_f32 v15, v15, v126, v127
    v_and_b32 v176, 15, v0
    v_lshrrev_b32 v177, 4, v0
    v_mul_u32_u24 v178, 12288, v176
    v_lshl_add_u32 v240, v177, 4, v178
    v_mul_u32_u24 v178, 768, v177
    v_lshl_add_u32 v242, v176, 4, v178
    s_lshl_b32 s83, s65, 1
    s_add_u32 s83, s83, s64
    s_mul_i32 s83, s83, 196608
    s_waitcnt vmcnt(6)
    s_add_u32 s11, s10, 6
    v_subrev_u32 v252, s11, v252
    v_cmp_gt_u32 s[12:13], 10, v252
    s_nop 0
    s_bcnt1_i32_b64 s11, s[12:13]
    s_cmp_le_u32 s11, 0
    s_cselect_b32 s81, 2, 1
    s_cmp_ge_u32 s11, 26
    s_cselect_b32 s81, 0, s81
    s_cmp_eq_u32 s81, 0
    s_cbranch_scc1 L_t15
    s_waitcnt vmcnt(4)
L_t15:
    buffer_load_dwordx4 v4, s[20:23], s61 offen offset:2048 nt lds
    s_lshl_b32 s84, s3, 8
    s_add_u32 s83, s83, s84
    s_add_u32 s83, s83, 8388608
    s_mul_i32 s84, s63, 768
    s_add_u32 s4, s83, s84
    s_mul_i32 s84, s63, 12288
    s_add_u32 s6, s83, s84
    s_add_u32 s7, s6, 6144
    v_cmp_eq_u32 vcc, 3, v177
    v_bfe_u32 v178, v0, 2, 2
    s_nop 0
    v_cndmask_b32 v177, v177, 1, vcc
    v_mad_u32_u24 v178, v178, 3, v177
    v_and_b32 v179, 3, v178
    v_mul_u32_u24 v179, 12, v179
    v_and_b32 v178, 12, v178
    v_add_u32 v179, v179, v178
    v_and_b32 v178, 3, v0
    v_mad_u32_u24 v241, v178, 48, v179
    s_lshr_b32 s83, s76, 1
    s_mul_i32 s8, s83, 1152
    s_mul_i32 s83, s64, 576
    s_add_u32 s8, s8, s83
    s_mul_i32 s83, s3, 192
    s_add_u32 s8, s8, s83
    s_lshl_b32 s83, s3, 10
    s_add_u32 s83, s83, 131072
    v_add_u32 v243, s83, v10
    s_add_u32 s83, s3, 0
    s_and_b32 s83, s83, 3
    s_mul_i32 s56, s83, 36864
    s_cmp_eq_u32 s81, 0
    s_cbranch_scc1 L_t16
    s_waitcnt vmcnt(4)
L_t16:
    buffer_load_dwordx4 v5, s[20:23], s61 offen offset:3072 nt lds
    s_add_u32 s83, s3, 1
    s_and_b32 s83, s83, 3
    s_mul_i32 s57, s83, 36864
    s_lshl_b32 s83, s83, 10
    s_add_u32 s83, s83, 131072
    v_add_u32 v244, s83, v10
    s_add_u32 s83, s3, 2
    s_and_b32 s83, s83, 3
    s_mul_i32 s58, s83, 36864
    s_lshl_b32 s83, s83, 10
    s_add_u32 s83, s83, 131072
    v_add_u32 v245, s83, v10
    s_add_u32 s83, s3, 3
    s_and_b32 s83, s83, 3
    s_mul_i32 s59, s83, 36864
    s_lshl_b32 s83, s83, 10
    s_add_u32 s83, s83, 131072
    v_add_u32 v246, s83, v10
    s_lshl_b32 s77, s76, 14
    s_lshl_b32 s83, s3, 12
    s_add_u32 s77, s77, s83
    s_xor_b32 s78, s77, 16384
    s_add_u32 s77, s77, 1048576
    s_add_u32 s78, s78, 1048576
    s_mov_b32 s28, s40
    s_mov_b32 s29, s41
    s_mov_b32 s31, 0x20000
    s_mov_b32 s36, s40
    s_mov_b32 s37, s41
    s_mov_b32 s39, 0x20000
    s_add_u32 s11, s10, 7
    v_mov_b32 v254, s11
    buffer_store_dword v254, v255, s[72:75], s9 offen
    buffer_load_dword v252, v253, s[40:43], s9 offen nt
    v_lshrrev_b32 v176, 4, v0
    v_and_b32 v177, 15, v0
    v_lshlrev_b32 v178, 1, v176
    v_xor_b32 v177, v177, v178
    v_lshlrev_b32 v177, 4, v177
    v_lshl_add_u32 v2, v176, 8, v177
    v_xor_b32 v3, 0x80, v2
    s_lshl_b32 s83, s3, 11
    s_add_u32 s83, s83, 131072
    v_add_u32 v4, s83, v10
    v_add_u32 v5, 131072, v10
    s_cmp_eq_u32 s81, 0
    s_cbranch_scc1 L_t17
    s_waitcnt vmcnt(6)
L_t17:
    s_mov_b32 s61, 0
    s_add_u32 m0, s62, 0
    s_nop 0
    buffer_load_dwordx4 v2, s[24:27], s61 offen offset:0 nt lds
    ds_read_b128 a[192:195], v6 offset:16384
    ds_read_b128 a[196:199], v7 offset:16384
    ds_read_b128 a[200:203], v8 offset:16384
    ds_read_b128 a[204:207], v9 offset:16384
    ds_read_b128 a[208:211], v6 offset:20480
    ds_read_b128 a[212:215], v7 offset:20480
    ds_read_b128 a[216:219], v8 offset:20480
    ds_read_b128 a[220:223], v9 offset:20480
    s_waitcnt lgkmcnt(0)
    v_mfma_f32_16x16x32_bf16 v[144:147], a[192:195], v[16:19], 0
    v_mfma_f32_16x16x32_bf16 v[152:155], a[192:195], v[32:35], 0
    s_cmp_eq_u32 s81, 0
    s_cbranch_scc1 L_t18
    s_waitcnt vmcnt(6)
L_t18:
    buffer_load_dwordx4 v3, s[24:27], s61 offen offset:1024 nt lds
    v_mfma_f32_16x16x32_bf16 v[148:151], a[208:211], v[16:19], 0
    v_mfma_f32_16x16x32_bf16 v[156:159], a[208:211], v[32:35], 0
    v_mfma_f32_16x16x32_bf16 v[144:147], a[196:199], v[20:23], v[144:147]
    s_cmp_eq_u32 s81, 0
    s_cbranch_scc1 L_t19
    s_waitcnt vmcnt(6)
L_t19:
    buffer_load_dwordx4 v2, s[24:27], s61 offen offset:2048 nt lds
    v_mfma_f32_16x16x32_bf16 v[152:155], a[196:199], v[36:39], v[152:155]
    v_mfma_f32_16x16x32_bf16 v[148:151], a[212:215], v[20:23], v[148:151]
    s_cmp_eq_u32 s81, 0
    s_cbranch_scc1 L_t20
    s_waitcnt vmcnt(6)
L_t20:
    buffer_load_dwordx4 v3, s[24:27], s61 offen offset:3072 nt lds
    v_mfma_f32_16x16x32_bf16 v[156:159], a[212:215], v[36:39], v[156:159]
    v_mfma_f32_16x16x32_bf16 v[144:147], a[200:203], v[24:27], v[144:147]
    s_cmp_eq_u32 s81, 0
    s_cbranch_scc1 L_t21
    s_waitcnt vmcnt(6)
L_t21:
    s_mov_b32 s61, 4096
    s_add_u32 m0, s62, 4096
    s_nop 0
    buffer_load_dwordx4 v2, s[24:27], s61 offen offset:0 nt lds
    v_mfma_f32_16x16x32_bf16 v[152:155], a[200:203], v[40:43], v[152:155]
    v_mfma_f32_16x16x32_bf16 v[148:151], a[216:219], v[24:27], v[148:151]
    v_mfma_f32_16x16x32_bf16 v[156:159], a[216:219], v[40:43], v[156:159]
    s_cmp_eq_u32 s81, 0
    s_cbranch_scc1 L_t22
    s_waitcnt vmcnt(4)
L_t22:
    buffer_load_dwordx4 v3, s[24:27], s61 offen offset:1024 nt lds
    v_mfma_f32_16x16x32_bf16 v[144:147], a[204:207], v[28:31], v[144:147]
    v_mfma_f32_16x16x32_bf16 v[152:155], a[204:207], v[44:47], v[152:155]
    s_waitcnt vmcnt(6)
    s_add_u32 s11, s10, 7
    v_subrev_u32 v252, s11, v252
    v_cmp_gt_u32 s[12:13], 9, v252
    s_nop 0
    s_bcnt1_i32_b64 s11, s[12:13]
    s_cmp_le_u32 s11, 0
    s_cselect_b32 s81, 2, 1
    s_cmp_ge_u32 s11, 26
    s_cselect_b32 s81, 0, s81
    s_cmp_eq_u32 s81, 0
    s_cbranch_scc1 L_t23
    s_waitcnt vmcnt(4)
L_t23:
    buffer_load_dwordx4 v2, s[24:27], s61 offen offset:2048 nt lds
    v_mfma_f32_16x16x32_bf16 v[148:151], a[220:223], v[28:31], v[148:151]
    v_mfma_f32_16x16x32_bf16 v[156:159], a[220:223], v[44:47], v[156:159]
    v_max3_f32 v14, v14, v128, v129
    s_cmp_eq_u32 s81, 0
    s_cbranch_scc1 L_t24
    s_waitcnt vmcnt(4)
L_t24:
    buffer_load_dwordx4 v3, s[24:27], s61 offen offset:3072 nt lds
    s_add_u32 s11, s10, 8
    v_mov_b32 v254, s11
    buffer_store_dword v254, v255, s[72:75], s9 offen
    buffer_load_dword v252, v253, s[40:43], s9 offen nt
    v_max3_f32 v15, v15, v136, v137
    v_max3_f32 v14, v14, v130, v131
    v_max3_f32 v15, v15, v138, v139
    v_max3_f32 v14, v14, v132, v133
    v_max3_f32 v15, v15, v140, v141
    v_max3_f32 v14, v14, v134, v135
    v_max3_f32 v15, v15, v142, v143
    s_cmp_eq_u32 s81, 0
    s_cbranch_scc1 L_t25
    s_waitcnt vmcnt(6)
L_t25:
    s_mov_b32 s61, 8192
    s_add_u32 m0, s62, 8192
    s_nop 0
    buffer_load_dwordx4 v2, s[24:27], s61 offen offset:0 nt lds
    ds_read_b128 a[224:227], v6 offset:24576
    ds_read_b128 a[228:231], v7 offset:24576
    ds_read_b128 a[232:235], v8 offset:24576
    ds_read_b128 a[236:239], v9 offset:24576
    ds_read_b128 a[240:243], v6 offset:28672
    ds_read_b128 a[244:247], v7 offset:28672
    ds_read_b128 a[248:251], v8 offset:28672
    ds_read_b128 a[252:255], v9 offset:28672
    s_waitcnt lgkmcnt(0)
    v_mfma_f32_16x16x32_bf16 v[160:163], a[224:227], v[16:19], 0
    v_mfma_f32_16x16x32_bf16 v[168:171], a[224:227], v[32:35], 0
    v_mfma_f32_16x16x32_bf16 v[164:167], a[240:243], v[16:19], 0
    v_mfma_f32_16x16x32_bf16 v[172:175], a[240:243], v[32:35], 0
    v_mfma_f32_16x16x32_bf16 v[160:163], a[228:231], v[20:23], v[160:163]
    s_cmp_eq_u32 s81, 0
    s_cbranch_scc1 L_t26
    s_waitcnt vmcnt(6)
L_t26:
    buffer_load_dwordx4 v3, s[24:27], s61 offen offset:1024 nt lds
    v_mfma_f32_16x16x32_bf16 v[168:171], a[228:231], v[36:39], v[168:171]
    v_mfma_f32_16x16x32_bf16 v[164:167], a[244:247], v[20:23], v[164:167]
    v_mfma_f32_16x16x32_bf16 v[172:175], a[244:247], v[36:39], v[172:175]
    v_mfma_f32_16x16x32_bf16 v[160:163], a[232:235], v[24:27], v[160:163]
    v_mfma_f32_16x16x32_bf16 v[168:171], a[232:235], v[40:43], v[168:171]
    s_cmp_eq_u32 s81, 0
    s_cbranch_scc1 L_t27
    s_waitcnt vmcnt(6)
L_t27:
    buffer_load_dwordx4 v2, s[24:27], s61 offen offset:2048 nt lds
    v_mfma_f32_16x16x32_bf16 v[164:167], a[248:251], v[24:27], v[164:167]
    v_mfma_f32_16x16x32_bf16 v[172:175], a[248:251], v[40:43], v[172:175]
    v_mfma_f32_16x16x32_bf16 v[160:163], a[236:239], v[28:31], v[160:163]
    v_mfma_f32_16x16x32_bf16 v[168:171], a[236:239], v[44:47], v[168:171]
    v_mfma_f32_16x16x32_bf16 v[164:167], a[252:255], v[28:31], v[164:167]
    v_mfma_f32_16x16x32_bf16 v[172:175], a[252:255], v[44:47], v[172:175]
    s_cmp_eq_u32 s81, 0
    s_cbranch_scc1 L_t28
    s_waitcnt vmcnt(6)
L_t28:
    buffer_load_dwordx4 v3, s[24:27], s61 offen offset:3072 nt lds
    v_max3_f32 v14, v14, v144, v145
    v_max3_f32 v15, v15, v152, v153
    v_max3_f32 v14, v14, v146, v147
    v_max3_f32 v15, v15, v154, v155
    v_max3_f32 v14, v14, v148, v149
    v_max3_f32 v15, v15, v156, v157
    v_max3_f32 v14, v14, v150, v151
    v_max3_f32 v15, v15, v158, v159
    v_and_b32 v176, 15, v0
    v_lshlrev_b32 v176, 3, v176
    v_add_u32 v176, 31744, v176
    v_add_u32 v177, s62, v176
    v_add_u32 v188, 65536, v176
    v_max3_f32 v14, v14, v160, v161
    s_cmp_eq_u32 s81, 0
    s_cbranch_scc1 L_t29
    s_waitcnt vmcnt(6)
L_t29:
    s_mov_b32 s61, 12288
    s_add_u32 m0, s62, 12288
    s_nop 0
    buffer_load_dwordx4 v2, s[24:27], s61 offen offset:0 nt lds
    v_max3_f32 v15, v15, v168, v169
    v_max3_f32 v14, v14, v162, v163
    v_max3_f32 v15, v15, v170, v171
    v_max3_f32 v14, v14, v164, v165
    v_max3_f32 v15, v15, v172, v173
    v_max3_f32 v14, v14, v166, v167
    v_max3_f32 v15, v15, v174, v175
    v_mov_b32 v178, v14
    v_mov_b32 v179, v15
    s_nop 0
    v_permlane32_swap_b32 v178, v14
    v_permlane32_swap_b32 v179, v15
    v_max_f32 v14, v14, v178
    v_max_f32 v15, v15, v179
    v_mov_b32 v178, v14
    v_mov_b32 v179, v15
    s_nop 0
    v_permlane16_swap_b32 v178, v14
    s_cmp_eq_u32 s81, 0
    s_cbranch_scc1 L_t30
    s_waitcnt vmcnt(4)
L_t30:
    buffer_load_dwordx4 v3, s[24:27], s61 offen offset:1024 nt lds
    v_permlane16_swap_b32 v179, v15
    v_max_f32 v14, v14, v178
    v_max_f32 v15, v15, v179
    ds_write_b64 v177, v[14:15]
    s_waitcnt lgkmcnt(0)
    s_barrier
    ds_read_b64 v[180:181], v176
    ds_read_b64 v[182:183], v176 offset:32768
    ds_read_b64 v[184:185], v188
    ds_read_b64 v[186:187], v188 offset:32768
    s_waitcnt lgkmcnt(0)
    v_max3_f32 v14, v180, v182, v184
    v_max3_f32 v15, v181, v183, v185
    v_max_f32 v14, v14, v186
    v_max_f32 v15, v15, v187
    v_mul_f32 v14, s50, v14
    v_mul_f32 v15, s50, v15
    v_lshrrev_b32 v178, 2, v0
    v_and_b32 v179, 7, v178
    v_lshlrev_b32 v179, 1, v179
    v_bfe_u32 v180, v0, 1, 1
    s_lshl_b32 s83, s3, 2
    v_or_b32 v180, s83, v180
    v_xor_b32 v179, v179, v180
    v_lshlrev_b32 v179, 4, v179
    v_lshl_add_u32 v179, v178, 8, v179
    v_and_b32 v180, 1, v0
    v_lshl_add_u32 v6, v180, 3, v179
    v_xor_b32 v7, 32, v6
    v_add_u32 v8, 65536, v6
    v_add_u32 v9, 65536, v7
    s_waitcnt vmcnt(6)
    s_add_u32 s11, s10, 8
    v_subrev_u32 v252, s11, v252
    v_cmp_gt_u32 s[12:13], 8, v252
    s_nop 0
    s_bcnt1_i32_b64 s11, s[12:13]
    s_cmp_le_u32 s11, 0
    s_cselect_b32 s81, 2, 1
    s_cmp_ge_u32 s11, 26
    s_cselect_b32 s81, 0, s81
    s_cmp_eq_u32 s81, 0
    s_cbranch_scc1 L_t31
    s_waitcnt vmcnt(4)
L_t31:
    buffer_load_dwordx4 v2, s[24:27], s61 offen offset:2048 nt lds
    v_mov_b32 v176, 0x3f803f80
    v_mov_b32 v177, 0x3f803f80
    v_mov_b32 v178, 0x3f803f80
    v_mov_b32 v179, 0x3f803f80
    v_fma_f32 v48, v48, s50, -v14
    v_fma_f32 v49, v49, s50, -v14
    v_fma_f32 v50, v50, s50, -v14
    v_fma_f32 v51, v51, s50, -v14
    v_fma_f32 v52, v52, s50, -v14
    v_fma_f32 v53, v53, s50, -v14
    v_fma_f32 v54, v54, s50, -v14
    v_fma_f32 v55, v55, s50, -v14
    v_exp_f32 v48, v48
    v_exp_f32 v49, v49
    v_exp_f32 v50, v50
    v_exp_f32 v51, v51
    v_exp_f32 v52, v52
    v_exp_f32 v53, v53
    v_exp_f32 v54, v54
    v_exp_f32 v55, v55
    v_fma_f32 v56, v56, s50, -v15
    v_fma_f32 v57, v57, s50, -v15
    v_fma_f32 v58, v58, s50, -v15
    v_fma_f32 v59, v59, s50, -v15
    v_fma_f32 v60, v60, s50, -v15
    v_fma_f32 v61, v61, s50, -v15
    v_fma_f32 v62, v62, s50, -v15
    v_fma_f32 v63, v63, s50, -v15
    v_exp_f32 v56, v56
    v_exp_f32 v57, v57
    v_exp_f32 v58, v58
    v_exp_f32 v59, v59
    v_exp_f32 v60, v60
    v_exp_f32 v61, v61
    v_exp_f32 v62, v62
    v_exp_f32 v63, v63
    s_cmp_eq_u32 s81, 0
    s_cbranch_scc1 L_t32
    s_waitcnt vmcnt(4)
L_t32:
    buffer_load_dwordx4 v3, s[24:27], s61 offen offset:3072 nt lds
    s_add_u32 s11, s10, 9
    v_mov_b32 v254, s11
    buffer_store_dword v254, v255, s[72:75], s9 offen
    buffer_load_dword v252, v253, s[40:43], s9 offen nt
    v_cvt_pk_bf16_f32 v48, v48, v49
    v_cvt_pk_bf16_f32 v49, v50, v51
    v_cvt_pk_bf16_f32 v50, v52, v53
    v_cvt_pk_bf16_f32 v51, v54, v55
    v_cvt_pk_bf16_f32 v52, v56, v57
    v_cvt_pk_bf16_f32 v53, v58, v59
    v_cvt_pk_bf16_f32 v54, v60, v61
    v_cvt_pk_bf16_f32 v55, v62, v63
    v_fma_f32 v64, v64, s50, -v14
    v_fma_f32 v65, v65, s50, -v14
    v_fma_f32 v66, v66, s50, -v14
    v_fma_f32 v67, v67, s50, -v14
    v_fma_f32 v68, v68, s50, -v14
    v_fma_f32 v69, v69, s50, -v14
    v_fma_f32 v70, v70, s50, -v14
    v_fma_f32 v71, v71, s50, -v14
    v_exp_f32 v64, v64
    v_exp_f32 v65, v65
    v_exp_f32 v66, v66
    v_exp_f32 v67, v67
    v_exp_f32 v68, v68
    v_exp_f32 v69, v69
    v_exp_f32 v70, v70
    v_exp_f32 v71, v71
    v_fma_f32 v72, v72, s50, -v15
    v_fma_f32 v73, v73, s50, -v15
    v_fma_f32 v74, v74, s50, -v15
    v_fma_f32 v75, v75, s50, -v15
    v_fma_f32 v76, v76, s50, -v15
    v_fma_f32 v77, v77, s50, -v15
    v_fma_f32 v78, v78, s50, -v15
    v_fma_f32 v79, v79, s50, -v15
    v_exp_f32 v72, v72
    v_exp_f32 v73, v73
    v_exp_f32 v74, v74
    v_exp_f32 v75, v75
    v_exp_f32 v76, v76
    s_cmp_eq_u32 s81, 0
    s_cbranch_scc1 L_t33
    s_waitcnt vmcnt(6)
L_t33:
    s_mov_b32 s61, 16384
    s_add_u32 m0, s62, 16384
    s_nop 0
    buffer_load_dwordx4 v2, s[24:27], s61 offen offset:0 nt lds
    v_exp_f32 v77, v77
    v_exp_f32 v78, v78
    v_exp_f32 v79, v79
    v_cvt_pk_bf16_f32 v56, v64, v65
    v_cvt_pk_bf16_f32 v57, v66, v67
    v_cvt_pk_bf16_f32 v58, v68, v69
    v_cvt_pk_bf16_f32 v59, v70, v71
    v_cvt_pk_bf16_f32 v60, v72, v73
    v_cvt_pk_bf16_f32 v61, v74, v75
    v_cvt_pk_bf16_f32 v62, v76, v77
    v_cvt_pk_bf16_f32 v63, v78, v79
    v_mfma_f32_16x16x32_bf16 v[184:187], v[176:179], v[48:51], 0
    v_mfma_f32_16x16x32_bf16 v[188:191], v[176:179], v[52:55], 0
    v_fma_f32 v80, v80, s50, -v14
    v_fma_f32 v81, v81, s50, -v14
    v_fma_f32 v82, v82, s50, -v14
    v_fma_f32 v83, v83, s50, -v14
    v_fma_f32 v84, v84, s50, -v14
    v_fma_f32 v85, v85, s50, -v14
    v_fma_f32 v86, v86, s50, -v14
    v_fma_f32 v87, v87, s50, -v14
    v_exp_f32 v80, v80
    v_exp_f32 v81, v81
    v_exp_f32 v82, v82
    v_exp_f32 v83, v83
    v_exp_f32 v84, v84
    v_exp_f32 v85, v85
    v_exp_f32 v86, v86
    v_exp_f32 v87, v87
    v_fma_f32 v88, v88, s50, -v15
    v_fma_f32 v89, v89, s50, -v15
    v_fma_f32 v90, v90, s50, -v15
    v_fma_f32 v91, v91, s50, -v15
    v_fma_f32 v92, v92, s50, -v15
    v_fma_f32 v93, v93, s50, -v15
    v_fma_f32 v94, v94, s50, -v15
    s_cmp_eq_u32 s81, 0
    s_cbranch_scc1 L_t34
    s_waitcnt vmcnt(6)
L_t34:
    buffer_load_dwordx4 v3, s[24:27], s61 offen offset:1024 nt lds
    v_fma_f32 v95, v95, s50, -v15
    v_exp_f32 v88, v88
    v_exp_f32 v89, v89
    v_exp_f32 v90, v90
    v_exp_f32 v91, v91
    v_exp_f32 v92, v92
    v_exp_f32 v93, v93
    v_exp_f32 v94, v94
    v_exp_f32 v95, v95
    v_cvt_pk_bf16_f32 v64, v80, v81
    v_cvt_pk_bf16_f32 v65, v82, v83
    v_cvt_pk_bf16_f32 v66, v84, v85
    v_cvt_pk_bf16_f32 v67, v86, v87
    v_cvt_pk_bf16_f32 v68, v88, v89
    v_cvt_pk_bf16_f32 v69, v90, v91
    v_cvt_pk_bf16_f32 v70, v92, v93
    v_cvt_pk_bf16_f32 v71, v94, v95
    v_mfma_f32_16x16x32_bf16 v[184:187], v[176:179], v[56:59], v[184:187]
    v_mfma_f32_16x16x32_bf16 v[188:191], v[176:179], v[60:63], v[188:191]
    v_fma_f32 v96, v96, s50, -v14
    v_fma_f32 v97, v97, s50, -v14
    v_fma_f32 v98, v98, s50, -v14
    v_fma_f32 v99, v99, s50, -v14
    v_fma_f32 v100, v100, s50, -v14
    v_fma_f32 v101, v101, s50, -v14
    v_fma_f32 v102, v102, s50, -v14
    v_fma_f32 v103, v103, s50, -v14
    v_exp_f32 v96, v96
    v_exp_f32 v97, v97
    v_exp_f32 v98, v98
    v_exp_f32 v99, v99
    v_exp_f32 v100, v100
    v_exp_f32 v101, v101
    s_cmp_eq_u32 s81, 0
    s_cbranch_scc1 L_t35
    s_waitcnt vmcnt(6)
L_t35:
    buffer_load_dwordx4 v2, s[24:27], s61 offen offset:2048 nt lds
    v_exp_f32 v102, v102
    v_exp_f32 v103, v103
    v_fma_f32 v104, v104, s50, -v15
    v_fma_f32 v105, v105, s50, -v15
    v_fma_f32 v106, v106, s50, -v15
    v_fma_f32 v107, v107, s50, -v15
    v_fma_f32 v108, v108, s50, -v15
    v_fma_f32 v109, v109, s50, -v15
    v_fma_f32 v110, v110, s50, -v15
    v_fma_f32 v111, v111, s50, -v15
    v_exp_f32 v104, v104
    v_exp_f32 v105, v105
    v_exp_f32 v106, v106
    v_exp_f32 v107, v107
    v_exp_f32 v108, v108
    v_exp_f32 v109, v109
    v_exp_f32 v110, v110
    v_exp_f32 v111, v111
    v_cvt_pk_bf16_f32 v72, v96, v97
    v_cvt_pk_bf16_f32 v73, v98, v99
    v_cvt_pk_bf16_f32 v74, v100, v101
    v_cvt_pk_bf16_f32 v75, v102, v103
    v_cvt_pk_bf16_f32 v76, v104, v105
    v_cvt_pk_bf16_f32 v77, v106, v107
    v_cvt_pk_bf16_f32 v78, v108, v109
    v_cvt_pk_bf16_f32 v79, v110, v111
    v_mfma_f32_16x16x32_bf16 v[184:187], v[176:179], v[64:67], v[184:187]
    v_mfma_f32_16x16x32_bf16 v[188:191], v[176:179], v[68:71], v[188:191]
    v_fma_f32 v112, v112, s50, -v14
    v_fma_f32 v113, v113, s50, -v14
    v_fma_f32 v114, v114, s50, -v14
    v_fma_f32 v115, v115, s50, -v14
    v_fma_f32 v116, v116, s50, -v14
    v_fma_f32 v117, v117, s50, -v14
    v_fma_f32 v118, v118, s50, -v14
    v_fma_f32 v119, v119, s50, -v14
    v_exp_f32 v112, v112
    s_cmp_eq_u32 s81, 0
    s_cbranch_scc1 L_t36
    s_waitcnt vmcnt(6)
L_t36:
    buffer_load_dwordx4 v3, s[24:27], s61 offen offset:3072 nt lds
    v_exp_f32 v113, v113
    v_exp_f32 v114, v114
    v_exp_f32 v115, v115
    v_exp_f32 v116, v116
    v_exp_f32 v117, v117
    v_exp_f32 v118, v118
    v_exp_f32 v119, v119
    v_fma_f32 v120, v120, s50, -v15
    v_fma_f32 v121, v121, s50, -v15
    v_fma_f32 v122, v122, s50, -v15
    v_fma_f32 v123, v123, s50, -v15
    v_fma_f32 v124, v124, s50, -v15
    v_fma_f32 v125, v125, s50, -v15
    v_fma_f32 v126, v126, s50, -v15
    v_fma_f32 v127, v127, s50, -v15
    v_exp_f32 v120, v120
    v_exp_f32 v121, v121
    v_exp_f32 v122, v122
    v_exp_f32 v123, v123
    v_exp_f32 v124, v124
    v_exp_f32 v125, v125
    v_exp_f32 v126, v126
    v_exp_f32 v127, v127
    v_cvt_pk_bf16_f32 v80, v112, v113
    v_cvt_pk_bf16_f32 v81, v114, v115
    v_cvt_pk_bf16_f32 v82, v116, v117
    v_cvt_pk_bf16_f32 v83, v118, v119
    v_cvt_pk_bf16_f32 v84, v120, v121
    v_cvt_pk_bf16_f32 v85, v122, v123
    v_cvt_pk_bf16_f32 v86, v124, v125
    v_cvt_pk_bf16_f32 v87, v126, v127
    v_mfma_f32_16x16x32_bf16 v[184:187], v[176:179], v[72:75], v[184:187]
    v_mfma_f32_16x16x32_bf16 v[188:191], v[176:179], v[76:79], v[188:191]
    s_cmp_eq_u32 s81, 0
    s_cbranch_scc1 L_t37
    s_waitcnt vmcnt(6)
L_t37:
    s_mov_b32 s61, 20480
    s_add_u32 m0, s62, 20480
    s_nop 0
    buffer_load_dwordx4 v2, s[24:27], s61 offen offset:0 nt lds
    v_fma_f32 v128, v128, s50, -v14
    v_fma_f32 v129, v129, s50, -v14
    v_fma_f32 v130, v130, s50, -v14
    v_fma_f32 v131, v131, s50, -v14
    v_fma_f32 v132, v132, s50, -v14
    v_fma_f32 v133, v133, s50, -v14
    v_fma_f32 v134, v134, s50, -v14
    v_fma_f32 v135, v135, s50, -v14
    v_exp_f32 v128, v128
    v_exp_f32 v129, v129
    v_exp_f32 v130, v130
    v_exp_f32 v131, v131
    v_exp_f32 v132, v132
    v_exp_f32 v133, v133
    v_exp_f32 v134, v134
    v_exp_f32 v135, v135
    v_fma_f32 v136, v136, s50, -v15
    v_fma_f32 v137, v137, s50, -v15
    v_fma_f32 v138, v138, s50, -v15
    v_fma_f32 v139, v139, s50, -v15
    v_fma_f32 v140, v140, s50, -v15
    v_fma_f32 v141, v141, s50, -v15
    v_fma_f32 v142, v142, s50, -v15
    v_fma_f32 v143, v143, s50, -v15
    v_exp_f32 v136, v136
    v_exp_f32 v137, v137
    v_exp_f32 v138, v138
    v_exp_f32 v139, v139
    v_exp_f32 v140, v140
    v_exp_f32 v141, v141
    v_exp_f32 v142, v142
    v_exp_f32 v143, v143
    v_cvt_pk_bf16_f32 v88, v128, v129
    s_cmp_eq_u32 s81, 0
    s_cbranch_scc1 L_t38
    s_waitcnt vmcnt(4)
L_t38:
    buffer_load_dwordx4 v3, s[24:27], s61 offen offset:1024 nt lds
    v_cvt_pk_bf16_f32 v89, v130, v131
    v_cvt_pk_bf16_f32 v90, v132, v133
    v_cvt_pk_bf16_f32 v91, v134, v135
    v_cvt_pk_bf16_f32 v92, v136, v137
    v_cvt_pk_bf16_f32 v93, v138, v139
    v_cvt_pk_bf16_f32 v94, v140, v141
    v_cvt_pk_bf16_f32 v95, v142, v143
    v_mfma_f32_16x16x32_bf16 v[184:187], v[176:179], v[80:83], v[184:187]
    v_mfma_f32_16x16x32_bf16 v[188:191], v[176:179], v[84:87], v[188:191]
    v_fma_f32 v144, v144, s50, -v14
    v_fma_f32 v145, v145, s50, -v14
    v_fma_f32 v146, v146, s50, -v14
    v_fma_f32 v147, v147, s50, -v14
    v_fma_f32 v148, v148, s50, -v14
    v_fma_f32 v149, v149, s50, -v14
    v_fma_f32 v150, v150, s50, -v14
    v_fma_f32 v151, v151, s50, -v14
    v_exp_f32 v144, v144
    v_exp_f32 v145, v145
    v_exp_f32 v146, v146
    v_exp_f32 v147, v147
    v_exp_f32 v148, v148
    v_exp_f32 v149, v149
    v_exp_f32 v150, v150
    v_exp_f32 v151, v151
    v_fma_f32 v152, v152, s50, -v15
    v_fma_f32 v153, v153, s50, -v15
    v_fma_f32 v154, v154, s50, -v15
    v_fma_f32 v155, v155, s50, -v15
    v_fma_f32 v156, v156, s50, -v15
    v_fma_f32 v157, v157, s50, -v15
    v_fma_f32 v158, v158, s50, -v15
    v_fma_f32 v159, v159, s50, -v15
    v_exp_f32 v152, v152
    v_exp_f32 v153, v153
    v_exp_f32 v154, v154
    s_waitcnt vmcnt(6)
    s_add_u32 s11, s10, 9
    v_subrev_u32 v252, s11, v252
    v_cmp_gt_u32 s[12:13], 7, v252
    s_nop 0
    s_bcnt1_i32_b64 s11, s[12:13]
    s_cmp_le_u32 s11, 0
    s_cselect_b32 s81, 2, 1
    s_cmp_ge_u32 s11, 26
    s_cselect_b32 s81, 0, s81
    s_cmp_eq_u32 s81, 0
    s_cbranch_scc1 L_t39
    s_waitcnt vmcnt(4)
L_t39:
    buffer_load_dwordx4 v2, s[24:27], s61 offen offset:2048 nt lds
    v_exp_f32 v155, v155
    v_exp_f32 v156, v156
    v_exp_f32 v157, v157
    v_exp_f32 v158, v158
    v_exp_f32 v159, v159
    v_cvt_pk_bf16_f32 v96, v144, v145
    v_cvt_pk_bf16_f32 v97, v146, v147
    v_cvt_pk_bf16_f32 v98, v148, v149
    v_cvt_pk_bf16_f32 v99, v150, v151
    v_cvt_pk_bf16_f32 v100, v152, v153
    v_cvt_pk_bf16_f32 v101, v154, v155
    v_cvt_pk_bf16_f32 v102, v156, v157
    v_cvt_pk_bf16_f32 v103, v158, v159
    v_mfma_f32_16x16x32_bf16 v[184:187], v[176:179], v[88:91], v[184:187]
    v_mfma_f32_16x16x32_bf16 v[188:191], v[176:179], v[92:95], v[188:191]
    v_fma_f32 v160, v160, s50, -v14
    v_fma_f32 v161, v161, s50, -v14
    v_fma_f32 v162, v162, s50, -v14
    v_fma_f32 v163, v163, s50, -v14
    v_fma_f32 v164, v164, s50, -v14
    v_fma_f32 v165, v165, s50, -v14
    v_fma_f32 v166, v166, s50, -v14
    v_fma_f32 v167, v167, s50, -v14
    v_exp_f32 v160, v160
    v_exp_f32 v161, v161
    v_exp_f32 v162, v162
    v_exp_f32 v163, v163
    v_exp_f32 v164, v164
    v_exp_f32 v165, v165
    v_exp_f32 v166, v166
    v_exp_f32 v167, v167
    v_fma_f32 v168, v168, s50, -v15
    v_fma_f32 v169, v169, s50, -v15
    v_fma_f32 v170, v170, s50, -v15
    s_cmp_eq_u32 s81, 0
    s_cbranch_scc1 L_t40
    s_waitcnt vmcnt(4)
L_t40:
    buffer_load_dwordx4 v3, s[24:27], s61 offen offset:3072 nt lds
    s_add_u32 s11, s10, 10
    v_mov_b32 v254, s11
    buffer_store_dword v254, v255, s[72:75], s9 offen
    buffer_load_dword v252, v253, s[40:43], s9 offen nt
    v_fma_f32 v171, v171, s50, -v15
    v_fma_f32 v172, v172, s50, -v15
    v_fma_f32 v173, v173, s50, -v15
    v_fma_f32 v174, v174, s50, -v15
    v_fma_f32 v175, v175, s50, -v15
    v_exp_f32 v168, v168
    v_exp_f32 v169, v169
    v_exp_f32 v170, v170
    v_exp_f32 v171, v171
    v_exp_f32 v172, v172
    v_exp_f32 v173, v173
    v_exp_f32 v174, v174
    v_exp_f32 v175, v175
    v_cvt_pk_bf16_f32 v104, v160, v161
    v_cvt_pk_bf16_f32 v105, v162, v163
    v_cvt_pk_bf16_f32 v106, v164, v165
    v_cvt_pk_bf16_f32 v107, v166, v167
    v_cvt_pk_bf16_f32 v108, v168, v169
    v_cvt_pk_bf16_f32 v109, v170, v171
    v_cvt_pk_bf16_f32 v110, v172, v173
    v_cvt_pk_bf16_f32 v111, v174, v175
    v_mfma_f32_16x16x32_bf16 v[184:187], v[176:179], v[96:99], v[184:187]
    v_mfma_f32_16x16x32_bf16 v[188:191], v[176:179], v[100:103], v[188:191]
    v_mfma_f32_16x16x32_bf16 v[184:187], v[176:179], v[104:107], v[184:187]
    v_mfma_f32_16x16x32_bf16 v[188:191], v[176:179], v[108:111], v[188:191]
    v_and_b32 v1, 15, v0
    s_lshl_b32 s83, s3, 2
    v_lshl_add_u32 v1, v1, 4, s83
    v_add_u32 v1, 156160, v1
    s_nop 2
    ds_write_b32 v1, v184
    ds_write_b32 v1, v188 offset:256
    ds_write_b128 v4, v[48:51] offset:0
    ds_write_b128 v4, v[52:55] offset:1024
    ds_write_b128 v4, v[56:59] offset:8192
    ds_write_b128 v4, v[60:63] offset:9216
    s_cmp_eq_u32 s81, 0
    s_cbranch_scc1 L_t41
    s_waitcnt vmcnt(6)
L_t41:
    s_mov_b32 s61, 24576
    s_add_u32 m0, s62, 24576
    s_nop 0
    buffer_load_dwordx4 v2, s[24:27], s61 offen offset:0 nt lds
    s_waitcnt lgkmcnt(0)
    s_barrier
    v_and_b32 v1, 15, v0
    v_lshlrev_b32 v1, 4, v1
    v_add_u32 v1, 156160, v1
    ds_read_b128 v[176:179], v1
    ds_read_b128 v[180:183], v1 offset:256
    ds_read_b128 v[192:195], v5 offset:0
    ds_read_b128 v[196:199], v5 offset:1024
    ds_read_b64_tr_b16 v[16:17], v6 offset:0
    ds_read_b64_tr_b16 v[18:19], v6 offset:4096
    ds_read_b64_tr_b16 v[20:21], v7 offset:0
    ds_read_b64_tr_b16 v[22:23], v7 offset:4096
    ds_read_b128 v[200:203], v5 offset:2048
    ds_read_b128 v[204:207], v5 offset:3072
    ds_read_b64_tr_b16 v[24:25], v6 offset:32768
    ds_read_b64_tr_b16 v[26:27], v6 offset:36864
    ds_read_b64_tr_b16 v[28:29], v7 offset:32768
    ds_read_b64_tr_b16 v[30:31], v7 offset:36864
    ds_read_b128 v[208:211], v5 offset:4096
    ds_read_b128 v[212:215], v5 offset:5120
    ds_read_b64_tr_b16 v[32:33], v8 offset:0
    ds_read_b64_tr_b16 v[34:35], v8 offset:4096
    ds_read_b64_tr_b16 v[36:37], v9 offset:0
    ds_read_b64_tr_b16 v[38:39], v9 offset:4096
    ds_read_b128 v[216:219], v5 offset:6144
    ds_read_b128 v[220:223], v5 offset:7168
    ds_read_b64_tr_b16 v[40:41], v8 offset:32768
    ds_read_b64_tr_b16 v[42:43], v8 offset:36864
    ds_read_b64_tr_b16 v[44:45], v9 offset:32768
    ds_read_b64_tr_b16 v[46:47], v9 offset:36864
    ds_write_b128 v4, v[64:67] offset:16384
    ds_write_b128 v4, v[68:71] offset:17408
    s_waitcnt lgkmcnt(15)
    v_mfma_f32_16x16x32_bf16 v[224:227], v[16:19], v[192:195], 0
    v_mfma_f32_16x16x32_bf16 v[232:235], v[16:19], v[196:199], 0
    s_cmp_eq_u32 s81, 0
    s_cbranch_scc1 L_t42
    s_waitcnt vmcnt(6)
L_t42:
    buffer_load_dwordx4 v3, s[24:27], s61 offen offset:1024 nt lds
    v_mfma_f32_16x16x32_bf16 v[228:231], v[20:23], v[192:195], 0
    v_mfma_f32_16x16x32_bf16 v[236:239], v[20:23], v[196:199], 0
    v_mfma_f32_16x16x32_bf16 v[224:227], v[24:27], v[200:203], v[224:227]
    v_mfma_f32_16x16x32_bf16 v[232:235], v[24:27], v[204:207], v[232:235]
    s_waitcnt lgkmcnt(14)
    v_mfma_f32_16x16x32_bf16 v[228:231], v[28:31], v[200:203], v[228:231]
    s_cmp_eq_u32 s81, 0
    s_cbranch_scc1 L_t43
    s_waitcnt vmcnt(6)
L_t43:
    buffer_load_dwordx4 v2, s[24:27], s61 offen offset:2048 nt lds
    v_mfma_f32_16x16x32_bf16 v[236:239], v[28:31], v[204:207], v[236:239]
    s_waitcnt lgkmcnt(10)
    v_mfma_f32_16x16x32_bf16 v[224:227], v[32:35], v[208:211], v[224:227]
    v_mfma_f32_16x16x32_bf16 v[232:235], v[32:35], v[212:215], v[232:235]
    s_waitcnt lgkmcnt(8)
    v_mfma_f32_16x16x32_bf16 v[228:231], v[36:39], v[208:211], v[228:231]
    v_mfma_f32_16x16x32_bf16 v[236:239], v[36:39], v[212:215], v[236:239]
    s_waitcnt lgkmcnt(4)
    v_mfma_f32_16x16x32_bf16 v[224:227], v[40:43], v[216:219], v[224:227]
    s_cmp_eq_u32 s81, 0
    s_cbranch_scc1 L_t44
    s_waitcnt vmcnt(6)
L_t44:
    buffer_load_dwordx4 v3, s[24:27], s61 offen offset:3072 nt lds
    v_mfma_f32_16x16x32_bf16 v[232:235], v[40:43], v[220:223], v[232:235]
    s_waitcnt lgkmcnt(2)
    v_mfma_f32_16x16x32_bf16 v[228:231], v[44:47], v[216:219], v[228:231]
    v_mfma_f32_16x16x32_bf16 v[236:239], v[44:47], v[220:223], v[236:239]
    v_add_f32 v176, v176, v177
    v_add_f32 v180, v180, v181
    v_add_f32 v178, v178, v179
    v_add_f32 v182, v182, v183
    v_add_f32 v11, v176, v178
    v_add_f32 v12, v180, v182
    v_and_b32 v1, 16, v0
    s_cmp_eq_u32 s81, 0
    s_cbranch_scc1 L_t45
    s_waitcnt vmcnt(6)
L_t45:
    s_mov_b32 s61, 28672
    s_add_u32 m0, s62, 28672
    s_nop 0
    buffer_load_dwordx4 v2, s[24:27], s61 offen offset:0 nt lds
    v_cmp_eq_u32 vcc, 0, v1
    s_lshl_b32 s83, s80, 28
    s_xor_b32 s83, s83, s66
    v_mov_b32 v186, s66
    v_mov_b32 v187, s83
    v_cndmask_b32 v184, v15, v14, vcc
    v_cndmask_b32 v185, v12, v11, vcc
    v_and_b32 v1, 31, v0
    v_lshlrev_b32 v1, 4, v1
    s_lshl_b32 s83, s76, 9
    s_add_u32 s83, s83, 65536
    s_cmp_lg_u32 s3, 0
    s_cbranch_scc1 L_nostat
    buffer_store_dwordx4 v[184:187], v1, s[40:43], s83 offen sc1
    s_nop 1
L_nostat:
    s_waitcnt lgkmcnt(0)
    s_barrier
    ds_read_b128 v[192:195], v5 offset:8192
    ds_read_b128 v[196:199], v5 offset:9216
    ds_read_b64_tr_b16 v[16:17], v6 offset:8192
    ds_read_b64_tr_b16 v[18:19], v6 offset:12288
    ds_read_b64_tr_b16 v[20:21], v7 offset:8192
    ds_read_b64_tr_b16 v[22:23], v7 offset:12288
    ds_read_b128 v[200:203], v5 offset:10240
    ds_read_b128 v[204:207], v5 offset:11264
    ds_read_b64_tr_b16 v[24:25], v6 offset:40960
    ds_read_b64_tr_b16 v[26:27], v6 offset:45056
    ds_read_b64_tr_b16 v[28:29], v7 offset:40960
    ds_read_b64_tr_b16 v[30:31], v7 offset:45056
    ds_read_b128 v[208:211], v5 offset:12288
    ds_read_b128 v[212:215], v5 offset:13312
    ds_read_b64_tr_b16 v[32:33], v8 offset:8192
    ds_read_b64_tr_b16 v[34:35], v8 offset:12288
    ds_read_b64_tr_b16 v[36:37], v9 offset:8192
    ds_read_b64_tr_b16 v[38:39], v9 offset:12288
    ds_read_b128 v[216:219], v5 offset:14336
    s_cmp_eq_u32 s81, 0
    s_cbranch_scc1 L_t46
    s_waitcnt vmcnt(4)
L_t46:
    buffer_load_dwordx4 v3, s[24:27], s61 offen offset:1024 nt lds
    ds_read_b128 v[220:223], v5 offset:15360
    ds_read_b64_tr_b16 v[40:41], v8 offset:40960
    ds_read_b64_tr_b16 v[42:43], v8 offset:45056
    ds_read_b64_tr_b16 v[44:45], v9 offset:40960
    ds_read_b64_tr_b16 v[46:47], v9 offset:45056
    ds_write_b128 v4, v[72:75] offset:0
    ds_write_b128 v4, v[76:79] offset:1024
    s_waitcnt lgkmcnt(15)
    v_mfma_f32_16x16x32_bf16 v[224:227], v[16:19], v[192:195], v[224:227]
    v_mfma_f32_16x16x32_bf16 v[232:235], v[16:19], v[196:199], v[232:235]
    v_mfma_f32_16x16x32_bf16 v[228:231], v[20:23], v[192:195], v[228:231]
    v_mfma_f32_16x16x32_bf16 v[236:239], v[20:23], v[196:199], v[236:239]
    v_mfma_f32_16x16x32_bf16 v[224:227], v[24:27], v[200:203], v[224:227]
    s_waitcnt vmcnt(6)
    s_add_u32 s11, s10, 10
    v_subrev_u32 v252, s11, v252
    v_cmp_gt_u32 s[12:13], 6, v252
    s_nop 0
    s_bcnt1_i32_b64 s11, s[12:13]
    s_cmp_le_u32 s11, 0
    s_cselect_b32 s81, 2, 1
    s_cmp_ge_u32 s11, 26
    s_cselect_b32 s81, 0, s81
    s_cmp_eq_u32 s81, 0
    s_cbranch_scc1 L_t47
    s_waitcnt vmcnt(4)
L_t47:
    buffer_load_dwordx4 v2, s[24:27], s61 offen offset:2048 nt lds
    v_mfma_f32_16x16x32_bf16 v[232:235], v[24:27], v[204:207], v[232:235]
    s_waitcnt lgkmcnt(14)
    v_mfma_f32_16x16x32_bf16 v[228:231], v[28:31], v[200:203], v[228:231]
    v_mfma_f32_16x16x32_bf16 v[236:239], v[28:31], v[204:207], v[236:239]
    s_waitcnt lgkmcnt(10)
    v_mfma_f32_16x16x32_bf16 v[224:227], v[32:35], v[208:211], v[224:227]
    v_mfma_f32_16x16x32_bf16 v[232:235], v[32:35], v[212:215], v[232:235]
    s_waitcnt lgkmcnt(8)
    v_mfma_f32_16x16x32_bf16 v[228:231], v[36:39], v[208:211], v[228:231]
    s_cmp_eq_u32 s81, 0
    s_cbranch_scc1 L_t48
    s_waitcnt vmcnt(4)
L_t48:
    buffer_load_dwordx4 v3, s[24:27], s61 offen offset:3072 nt lds
    v_mfma_f32_16x16x32_bf16 v[236:239], v[36:39], v[212:215], v[236:239]
    s_waitcnt lgkmcnt(4)
    v_mfma_f32_16x16x32_bf16 v[224:227], v[40:43], v[216:219], v[224:227]
    v_mfma_f32_16x16x32_bf16 v[232:235], v[40:43], v[220:223], v[232:235]
    s_waitcnt lgkmcnt(2)
    v_mfma_f32_16x16x32_bf16 v[228:231], v[44:47], v[216:219], v[228:231]
    v_mfma_f32_16x16x32_bf16 v[236:239], v[44:47], v[220:223], v[236:239]
    s_waitcnt lgkmcnt(0)
    s_mov_b32 s79, 32768
    s_add_u32 s53, s62, 0
    s_cmp_eq_u32 s64, 0
    s_nop 3
    s_cbranch_scc1 L_OB
    s_mov_b32 s61, 32768
    s_add_u32 m0, s62, 0
    s_nop 0
    buffer_load_dwordx4 v2, s[24:27], s61 offen offset:0 nt lds
    buffer_load_dwordx4 v3, s[24:27], s61 offen offset:1024 nt lds
    s_waitcnt vmcnt(9)
    buffer_load_dwordx4 v2, s[24:27], s61 offen offset:2048 nt lds
    s_waitcnt vmcnt(9)
    buffer_load_dwordx4 v3, s[24:27], s61 offen offset:3072 nt lds
    s_waitcnt vmcnt(9)
    s_mov_b32 s61, 36864
    s_add_u32 m0, s62, 4096
    s_nop 0
    buffer_load_dwordx4 v2, s[24:27], s61 offen offset:0 nt lds
    s_waitcnt vmcnt(9)
    buffer_load_dwordx4 v3, s[24:27], s61 offen offset:1024 nt lds
    s_waitcnt vmcnt(9)
    buffer_load_dwordx4 v2, s[24:27], s61 offen offset:2048 nt lds
    s_waitcnt vmcnt(9)
    buffer_load_dwordx4 v3, s[24:27], s61 offen offset:3072 nt lds
L_OB_ret0:
    s_waitcnt lgkmcnt(0)
    s_barrier
    s_waitcnt vmcnt(9)
    s_mov_b32 s61, 40960
    s_add_u32 m0, s62, 8192
    s_nop 0
    buffer_load_dwordx4 v2, s[24:27], s61 offen offset:0 nt lds
    ds_read_b128 v[192:195], v5 offset:16384
    ds_read_b128 v[196:199], v5 offset:17408
    ds_read_b64_tr_b16 v[16:17], v6 offset:16384
    ds_read_b64_tr_b16 v[18:19], v6 offset:20480
    ds_read_b64_tr_b16 v[20:21], v7 offset:16384
    ds_read_b64_tr_b16 v[22:23], v7 offset:20480
    ds_read_b128 v[200:203], v5 offset:18432
    ds_read_b128 v[204:207], v5 offset:19456
    ds_read_b64_tr_b16 v[24:25], v6 offset:49152
    ds_read_b64_tr_b16 v[26:27], v6 offset:53248
    ds_read_b64_tr_b16 v[28:29], v7 offset:49152
    ds_read_b64_tr_b16 v[30:31], v7 offset:53248
    ds_read_b128 v[208:211], v5 offset:20480
    ds_read_b128 v[212:215], v5 offset:21504
    ds_read_b64_tr_b16 v[32:33], v8 offset:16384
    ds_read_b64_tr_b16 v[34:35], v8 offset:20480
    ds_read_b64_tr_b16 v[36:37], v9 offset:16384
    ds_read_b64_tr_b16 v[38:39], v9 offset:20480
    ds_read_b128 v[216:219], v5 offset:22528
    ds_read_b128 v[220:223], v5 offset:23552
    ds_read_b64_tr_b16 v[40:41], v8 offset:49152
    ds_read_b64_tr_b16 v[42:43], v8 offset:53248
    ds_read_b64_tr_b16 v[44:45], v9 offset:49152
    ds_read_b64_tr_b16 v[46:47], v9 offset:53248
    ds_write_b128 v4, v[80:83] offset:8192
    ds_write_b128 v4, v[84:87] offset:9216
    s_waitcnt lgkmcnt(15)
    v_mfma_f32_16x16x32_bf16 v[224:227], v[16:19], v[192:195], v[224:227]
    v_mfma_f32_16x16x32_bf16 v[232:235], v[16:19], v[196:199], v[232:235]
    v_mfma_f32_16x16x32_bf16 v[228:231], v[20:23], v[192:195], v[228:231]
    s_waitcnt vmcnt(9)
    buffer_load_dwordx4 v3, s[24:27], s61 offen offset:1024 nt lds
    v_mfma_f32_16x16x32_bf16 v[236:239], v[20:23], v[196:199], v[236:239]
    v_mfma_f32_16x16x32_bf16 v[224:227], v[24:27], v[200:203], v[224:227]
    v_mfma_f32_16x16x32_bf16 v[232:235], v[24:27], v[204:207], v[232:235]
    s_waitcnt lgkmcnt(14)
    v_mfma_f32_16x16x32_bf16 v[228:231], v[28:31], v[200:203], v[228:231]
    s_waitcnt vmcnt(9)
    buffer_load_dwordx4 v2, s[24:27], s61 offen offset:2048 nt lds
    v_mfma_f32_16x16x32_bf16 v[236:239], v[28:31], v[204:207], v[236:239]
    s_waitcnt lgkmcnt(10)
    v_mfma_f32_16x16x32_bf16 v[224:227], v[32:35], v[208:211], v[224:227]
    v_mfma_f32_16x16x32_bf16 v[232:235], v[32:35], v[212:215], v[232:235]
    s_waitcnt lgkmcnt(8)
    v_mfma_f32_16x16x32_bf16 v[228:231], v[36:39], v[208:211], v[228:231]
    v_mfma_f32_16x16x32_bf16 v[236:239], v[36:39], v[212:215], v[236:239]
    s_waitcnt vmcnt(9)
    buffer_load_dwordx4 v3, s[24:27], s61 offen offset:3072 nt lds
    s_waitcnt lgkmcnt(4)
    v_mfma_f32_16x16x32_bf16 v[224:227], v[40:43], v[216:219], v[224:227]
    v_mfma_f32_16x16x32_bf16 v[232:235], v[40:43], v[220:223], v[232:235]
    s_waitcnt lgkmcnt(2)
    v_mfma_f32_16x16x32_bf16 v[228:231], v[44:47], v[216:219], v[228:231]
    v_mfma_f32_16x16x32_bf16 v[236:239], v[44:47], v[220:223], v[236:239]
    s_waitcnt lgkmcnt(0)
    s_barrier
    s_waitcnt vmcnt(9)
    s_mov_b32 s61, 45056
    s_add_u32 m0, s62, 12288
    s_nop 0
    buffer_load_dwordx4 v2, s[24:27], s61 offen offset:0 nt lds
    ds_read_b128 v[192:195], v5 offset:0
    ds_read_b128 v[196:199], v5 offset:1024
    ds_read_b64_tr_b16 v[16:17], v6 offset:24576
    ds_read_b64_tr_b16 v[18:19], v6 offset:28672
    ds_read_b64_tr_b16 v[20:21], v7 offset:24576
    ds_read_b64_tr_b16 v[22:23], v7 offset:28672
    ds_read_b128 v[200:203], v5 offset:2048
    ds_read_b128 v[204:207], v5 offset:3072
    ds_read_b64_tr_b16 v[24:25], v6 offset:57344
    ds_read_b64_tr_b16 v[26:27], v6 offset:61440
    ds_read_b64_tr_b16 v[28:29], v7 offset:57344
    ds_read_b64_tr_b16 v[30:31], v7 offset:61440
    ds_read_b128 v[208:211], v5 offset:4096
    ds_read_b128 v[212:215], v5 offset:5120
    ds_read_b64_tr_b16 v[32:33], v8 offset:24576
    ds_read_b64_tr_b16 v[34:35], v8 offset:28672
    ds_read_b64_tr_b16 v[36:37], v9 offset:24576
    ds_read_b64_tr_b16 v[38:39], v9 offset:28672
    ds_read_b128 v[216:219], v5 offset:6144
    ds_read_b128 v[220:223], v5 offset:7168
    ds_read_b64_tr_b16 v[40:41], v8 offset:57344
    ds_read_b64_tr_b16 v[42:43], v8 offset:61440
    ds_read_b64_tr_b16 v[44:45], v9 offset:57344
    ds_read_b64_tr_b16 v[46:47], v9 offset:61440
    ds_write_b128 v4, v[88:91] offset:16384
    ds_write_b128 v4, v[92:95] offset:17408
    s_waitcnt lgkmcnt(15)
    v_mfma_f32_16x16x32_bf16 v[224:227], v[16:19], v[192:195], v[224:227]
    v_mfma_f32_16x16x32_bf16 v[232:235], v[16:19], v[196:199], v[232:235]
    s_waitcnt vmcnt(9)
    buffer_load_dwordx4 v3, s[24:27], s61 offen offset:1024 nt lds
    v_mfma_f32_16x16x32_bf16 v[228:231], v[20:23], v[192:195], v[228:231]
    v_mfma_f32_16x16x32_bf16 v[236:239], v[20:23], v[196:199], v[236:239]
    v_mfma_f32_16x16x32_bf16 v[224:227], v[24:27], v[200:203], v[224:227]
    v_mfma_f32_16x16x32_bf16 v[232:235], v[24:27], v[204:207], v[232:235]
    s_waitcnt lgkmcnt(14)
    v_mfma_f32_16x16x32_bf16 v[228:231], v[28:31], v[200:203], v[228:231]
    s_waitcnt vmcnt(9)
    buffer_load_dwordx4 v2, s[24:27], s61 offen offset:2048 nt lds
    v_mfma_f32_16x16x32_bf16 v[236:239], v[28:31], v[204:207], v[236:239]
    s_waitcnt lgkmcnt(10)
    v_mfma_f32_16x16x32_bf16 v[224:227], v[32:35], v[208:211], v[224:227]
    v_mfma_f32_16x16x32_bf16 v[232:235], v[32:35], v[212:215], v[232:235]
    s_waitcnt lgkmcnt(8)
    v_mfma_f32_16x16x32_bf16 v[228:231], v[36:39], v[208:211], v[228:231]
    v_mfma_f32_16x16x32_bf16 v[236:239], v[36:39], v[212:215], v[236:239]
    s_waitcnt vmcnt(9)
    buffer_load_dwordx4 v3, s[24:27], s61 offen offset:3072 nt lds
    s_waitcnt lgkmcnt(4)
    v_mfma_f32_16x16x32_bf16 v[224:227], v[40:43], v[216:219], v[224:227]
    v_mfma_f32_16x16x32_bf16 v[232:235], v[40:43], v[220:223], v[232:235]
    s_waitcnt lgkmcnt(2)
    v_mfma_f32_16x16x32_bf16 v[228:231], v[44:47], v[216:219], v[228:231]
    v_mfma_f32_16x16x32_bf16 v[236:239], v[44:47], v[220:223], v[236:239]
    s_waitcnt vmcnt(9)
    s_mov_b32 s61, 49152
    s_add_u32 m0, s62, 16384
    s_nop 0
    buffer_load_dwordx4 v2, s[24:27], s61 offen offset:0 nt lds
    s_waitcnt vmcnt(9)
    s_waitcnt lgkmcnt(0)
    s_barrier
    ds_read_b128 v[192:195], v5 offset:8192
    ds_read_b128 v[196:199], v5 offset:9216
    ds_read_b64_tr_b16 v[16:17], v6 offset:0
    ds_read_b64_tr_b16 v[18:19], v6 offset:4096
    ds_read_b64_tr_b16 v[20:21], v7 offset:0
    ds_read_b64_tr_b16 v[22:23], v7 offset:4096
    ds_read_b128 v[200:203], v5 offset:10240
    ds_read_b128 v[204:207], v5 offset:11264
    ds_read_b64_tr_b16 v[24:25], v6 offset:32768
    ds_read_b64_tr_b16 v[26:27], v6 offset:36864
    ds_read_b64_tr_b16 v[28:29], v7 offset:32768
    ds_read_b64_tr_b16 v[30:31], v7 offset:36864
    ds_read_b128 v[208:211], v5 offset:12288
    ds_read_b128 v[212:215], v5 offset:13312
    ds_read_b64_tr_b16 v[32:33], v8 offset:0
    ds_read_b64_tr_b16 v[34:35], v8 offset:4096
    ds_read_b64_tr_b16 v[36:37], v9 offset:0
    ds_read_b64_tr_b16 v[38:39], v9 offset:4096
    ds_read_b128 v[216:219], v5 offset:14336
    ds_read_b128 v[220:223], v5 offset:15360
    ds_read_b64_tr_b16 v[40:41], v8 offset:32768
    ds_read_b64_tr_b16 v[42:43], v8 offset:36864
    ds_read_b64_tr_b16 v[44:45], v9 offset:32768
    ds_read_b64_tr_b16 v[46:47], v9 offset:36864
    buffer_load_dwordx4 v3, s[24:27], s61 offen offset:1024 nt lds
    ds_write_b128 v4, v[96:99] offset:0
    ds_write_b128 v4, v[100:103] offset:1024
    s_waitcnt lgkmcnt(15)
    v_mfma_f32_16x16x32_bf16 v[224:227], v[16:19], v[192:195], v[224:227]
    v_mfma_f32_16x16x32_bf16 v[232:235], v[16:19], v[196:199], v[232:235]
    s_waitcnt vmcnt(9)
    buffer_load_dwordx4 v2, s[24:27], s61 offen offset:2048 nt lds
    v_mfma_f32_16x16x32_bf16 v[228:231], v[20:23], v[192:195], v[228:231]
    v_mfma_f32_16x16x32_bf16 v[236:239], v[20:23], v[196:199], v[236:239]
    v_mfma_f32_16x16x32_bf16 v[224:227], v[24:27], v[200:203], v[224:227]
    s_waitcnt vmcnt(9)
    buffer_load_dwordx4 v3, s[24:27], s61 offen offset:3072 nt lds
    v_mfma_f32_16x16x32_bf16 v[232:235], v[24:27], v[204:207], v[232:235]
    s_waitcnt lgkmcnt(14)
    v_mfma_f32_16x16x32_bf16 v[228:231], v[28:31], v[200:203], v[228:231]
    s_waitcnt vmcnt(9)
    s_mov_b32 s61, 53248
    s_add_u32 m0, s62, 20480
    s_nop 0
    buffer_load_dwordx4 v2, s[24:27], s61 offen offset:0 nt lds
    v_mfma_f32_16x16x32_bf16 v[236:239], v[28:31], v[204:207], v[236:239]
    s_waitcnt lgkmcnt(10)
    v_mfma_f32_16x16x32_bf16 v[224:227], v[32:35], v[208:211], v[224:227]
    s_waitcnt vmcnt(9)
    buffer_load_dwordx4 v3, s[24:27], s61 offen offset:1024 nt lds
    v_mfma_f32_16x16x32_bf16 v[232:235], v[32:35], v[212:215], v[232:235]
    s_waitcnt lgkmcnt(8)
    v_mfma_f32_16x16x32_bf16 v[228:231], v[36:39], v[208:211], v[228:231]
    v_mfma_f32_16x16x32_bf16 v[236:239], v[36:39], v[212:215], v[236:239]
    s_waitcnt vmcnt(9)
    buffer_load_dwordx4 v2, s[24:27], s61 offen offset:2048 nt lds
    s_waitcnt lgkmcnt(4)
    v_mfma_f32_16x16x32_bf16 v[224:227], v[40:43], v[216:219], v[224:227]
    v_mfma_f32_16x16x32_bf16 v[232:235], v[40:43], v[220:223], v[232:235]
    s_waitcnt vmcnt(9)
    buffer_load_dwordx4 v3, s[24:27], s61 offen offset:3072 nt lds
    s_waitcnt lgkmcnt(2)
    v_mfma_f32_16x16x32_bf16 v[228:231], v[44:47], v[216:219], v[228:231]
    v_mfma_f32_16x16x32_bf16 v[236:239], v[44:47], v[220:223], v[236:239]
    s_lshl_b32 s83, s76, 14
    s_lshl_b32 s84, s3, 12
    s_add_u32 s83, s83, s84
    s_add_u32 s83, s83, 1048576
    v_lshl_add_u32 v176, v0, 7, s83
    s_mul_i32 s83, s3, 24
    s_sub_u32 s83, s83, 24
    v_add_u32 v177, s83, v0
    v_mul_u32_u24 v178, 10923, v177
    v_lshrrev_b32 v178, 16, v178
    v_mul_u32_u24 v178, 11520, v178
    v_lshl_add_u32 v178, v177, 7, v178
    s_lshl_b32 s83, s65, 1
    s_add_u32 s83, s83, s64
    s_mul_i32 s83, s83, 196608
    s_mul_i32 s84, s63, 768
    s_add_u32 s83, s83, s84
    s_add_u32 s83, s83, 8388608
    v_add_u32 v178, s83, v178
    v_cmp_gt_u32 vcc, 24, v0
    v_mov_b32 v179, 0x7ffffff0
    s_nop 0
    v_cndmask_b32 v176, v178, v176, vcc
    v_cmp_gt_u32 vcc, 48, v0
    s_nop 1
    v_cndmask_b32 v176, v179, v176, vcc
    v_cmp_lt_u32 vcc, 23, v0
    s_nop 1
    v_cndmask_b32 v176, v179, v176, vcc
    buffer_load_dword a255, v176, s[40:43], 0 offen
    v_and_b32 v1, 15, v0
    v_lshlrev_b32 v1, 4, v1
    s_xor_b32 s54, s76, 1
    s_lshl_b32 s54, s54, 9
    s_add_u32 s54, s54, 65536
    buffer_load_dwordx4 v[72:75], v1, s[40:43], s54 offen offset:0 sc1
    buffer_load_dwordx4 v[76:79], v1, s[40:43], s54 offen offset:256 sc1
    s_mov_b32 s79, 57344
    s_add_u32 s53, s62, 24576
    s_cmp_lg_u32 s64, 1
    s_cbranch_scc1 L_pre7
    s_waitcnt vmcnt(11)
    s_waitcnt lgkmcnt(0)
    s_barrier
    ds_read_b128 v[192:195], v5 offset:16384
    ds_read_b128 v[196:199], v5 offset:17408
    ds_read_b64_tr_b16 v[16:17], v6 offset:8192
    ds_read_b64_tr_b16 v[18:19], v6 offset:12288
    ds_read_b64_tr_b16 v[20:21], v7 offset:8192
    ds_read_b64_tr_b16 v[22:23], v7 offset:12288
    ds_read_b128 v[200:203], v5 offset:18432
    ds_read_b128 v[204:207], v5 offset:19456
    ds_read_b64_tr_b16 v[24:25], v6 offset:40960
    ds_read_b64_tr_b16 v[26:27], v6 offset:45056
    ds_read_b64_tr_b16 v[28:29], v7 offset:40960
    ds_read_b64_tr_b16 v[30:31], v7 offset:45056
    ds_read_b128 v[208:211], v5 offset:20480
    ds_read_b128 v[212:215], v5 offset:21504
    ds_read_b64_tr_b16 v[32:33], v8 offset:8192
    ds_read_b64_tr_b16 v[34:35], v8 offset:12288
    ds_read_b64_tr_b16 v[36:37], v9 offset:8192
    ds_read_b64_tr_b16 v[38:39], v9 offset:12288
    ds_read_b128 v[216:219], v5 offset:22528
    ds_read_b128 v[220:223], v5 offset:23552
    ds_read_b64_tr_b16 v[40:41], v8 offset:40960
    ds_read_b64_tr_b16 v[42:43], v8 offset:45056
    ds_read_b64_tr_b16 v[44:45], v9 offset:40960
    ds_read_b64_tr_b16 v[46:47], v9 offset:45056
    ds_write_b128 v4, v[104:107] offset:8192
    ds_write_b128 v4, v[108:111] offset:9216
    s_waitcnt lgkmcnt(15)
    v_mfma_f32_16x16x32_bf16 v[224:227], v[16:19], v[192:195], v[224:227]
    v_mfma_f32_16x16x32_bf16 v[232:235], v[16:19], v[196:199], v[232:235]
    v_mfma_f32_16x16x32_bf16 v[228:231], v[20:23], v[192:195], v[228:231]
    v_mfma_f32_16x16x32_bf16 v[236:239], v[20:23], v[196:199], v[236:239]
    v_mfma_f32_16x16x32_bf16 v[224:227], v[24:27], v[200:203], v[224:227]
    v_mfma_f32_16x16x32_bf16 v[232:235], v[24:27], v[204:207], v[232:235]
    s_waitcnt lgkmcnt(14)
    v_mfma_f32_16x16x32_bf16 v[228:231], v[28:31], v[200:203], v[228:231]
    v_mfma_f32_16x16x32_bf16 v[236:239], v[28:31], v[204:207], v[236:239]
    s_waitcnt lgkmcnt(10)
    v_mfma_f32_16x16x32_bf16 v[224:227], v[32:35], v[208:211], v[224:227]
    v_mfma_f32_16x16x32_bf16 v[232:235], v[32:35], v[212:215], v[232:235]
    s_waitcnt lgkmcnt(8)
    v_mfma_f32_16x16x32_bf16 v[228:231], v[36:39], v[208:211], v[228:231]
    v_mfma_f32_16x16x32_bf16 v[236:239], v[36:39], v[212:215], v[236:239]
    s_waitcnt lgkmcnt(4)
    v_mfma_f32_16x16x32_bf16 v[224:227], v[40:43], v[216:219], v[224:227]
    v_mfma_f32_16x16x32_bf16 v[232:235], v[40:43], v[220:223], v[232:235]
    s_waitcnt lgkmcnt(2)
    v_mfma_f32_16x16x32_bf16 v[228:231], v[44:47], v[216:219], v[228:231]
    v_mfma_f32_16x16x32_bf16 v[236:239], v[44:47], v[220:223], v[236:239]
    s_waitcnt lgkmcnt(0)
    s_nop 6
    s_branch L_OB
L_pre7:
    s_mov_b32 s61, 57344
    s_add_u32 m0, s62, 24576
    s_nop 0
    buffer_load_dwordx4 v2, s[24:27], s61 offen offset:0 nt lds
    buffer_load_dwordx4 v3, s[24:27], s61 offen offset:1024 nt lds
    buffer_load_dwordx4 v2, s[24:27], s61 offen offset:2048 nt lds
    s_waitcnt vmcnt(15)
    buffer_load_dwordx4 v3, s[24:27], s61 offen offset:3072 nt lds
    s_waitcnt vmcnt(15)
    s_mov_b32 s61, 61440
    s_add_u32 m0, s62, 28672
    s_nop 0
    buffer_load_dwordx4 v2, s[24:27], s61 offen offset:0 nt lds
    s_waitcnt vmcnt(15)
    buffer_load_dwordx4 v3, s[24:27], s61 offen offset:1024 nt lds
    s_waitcnt vmcnt(15)
    buffer_load_dwordx4 v2, s[24:27], s61 offen offset:2048 nt lds
    s_waitcnt vmcnt(15)
    buffer_load_dwordx4 v3, s[24:27], s61 offen offset:3072 nt lds
    s_waitcnt lgkmcnt(0)
    s_barrier
    ds_read_b128 v[192:195], v5 offset:16384
    ds_read_b128 v[196:199], v5 offset:17408
    ds_read_b64_tr_b16 v[16:17], v6 offset:8192
    ds_read_b64_tr_b16 v[18:19], v6 offset:12288
    ds_read_b64_tr_b16 v[20:21], v7 offset:8192
    ds_read_b64_tr_b16 v[22:23], v7 offset:12288
    ds_read_b128 v[200:203], v5 offset:18432
    ds_read_b128 v[204:207], v5 offset:19456
    ds_read_b64_tr_b16 v[24:25], v6 offset:40960
    ds_read_b64_tr_b16 v[26:27], v6 offset:45056
    ds_read_b64_tr_b16 v[28:29], v7 offset:40960
    ds_read_b64_tr_b16 v[30:31], v7 offset:45056
    ds_read_b128 v[208:211], v5 offset:20480
    ds_read_b128 v[212:215], v5 offset:21504
    ds_read_b64_tr_b16 v[32:33], v8 offset:8192
    ds_read_b64_tr_b16 v[34:35], v8 offset:12288
    ds_read_b64_tr_b16 v[36:37], v9 offset:8192
    ds_read_b64_tr_b16 v[38:39], v9 offset:12288
    ds_read_b128 v[216:219], v5 offset:22528
    ds_read_b128 v[220:223], v5 offset:23552
    ds_read_b64_tr_b16 v[40:41], v8 offset:40960
    ds_read_b64_tr_b16 v[42:43], v8 offset:45056
    ds_read_b64_tr_b16 v[44:45], v9 offset:40960
    ds_read_b64_tr_b16 v[46:47], v9 offset:45056
    ds_write_b128 v4, v[104:107] offset:8192
    ds_write_b128 v4, v[108:111] offset:9216
    s_waitcnt lgkmcnt(15)
    v_mfma_f32_16x16x32_bf16 v[224:227], v[16:19], v[192:195], v[224:227]
    v_mfma_f32_16x16x32_bf16 v[232:235], v[16:19], v[196:199], v[232:235]
    v_mfma_f32_16x16x32_bf16 v[228:231], v[20:23], v[192:195], v[228:231]
    v_mfma_f32_16x16x32_bf16 v[236:239], v[20:23], v[196:199], v[236:239]
    v_mfma_f32_16x16x32_bf16 v[224:227], v[24:27], v[200:203], v[224:227]
    v_mfma_f32_16x16x32_bf16 v[232:235], v[24:27], v[204:207], v[232:235]
    s_waitcnt lgkmcnt(14)
    v_mfma_f32_16x16x32_bf16 v[228:231], v[28:31], v[200:203], v[228:231]
    v_mfma_f32_16x16x32_bf16 v[236:239], v[28:31], v[204:207], v[236:239]
    s_waitcnt lgkmcnt(10)
    v_mfma_f32_16x16x32_bf16 v[224:227], v[32:35], v[208:211], v[224:227]
    v_mfma_f32_16x16x32_bf16 v[232:235], v[32:35], v[212:215], v[232:235]
    s_waitcnt lgkmcnt(8)
    v_mfma_f32_16x16x32_bf16 v[228:231], v[36:39], v[208:211], v[228:231]
    v_mfma_f32_16x16x32_bf16 v[236:239], v[36:39], v[212:215], v[236:239]
    s_waitcnt lgkmcnt(4)
    v_mfma_f32_16x16x32_bf16 v[224:227], v[40:43], v[216:219], v[224:227]
    v_mfma_f32_16x16x32_bf16 v[232:235], v[40:43], v[220:223], v[232:235]
    s_waitcnt lgkmcnt(2)
    v_mfma_f32_16x16x32_bf16 v[228:231], v[44:47], v[216:219], v[228:231]
    v_mfma_f32_16x16x32_bf16 v[236:239], v[44:47], v[220:223], v[236:239]
    s_waitcnt lgkmcnt(0)
    s_nop 6
L_OB_ret1:
    s_waitcnt vmcnt(8)
    v_xor_b32 v80, s66, v74
    v_xor_b32 v81, s66, v75
    v_xor_b32 v82, s66, v78
    v_xor_b32 v83, s66, v79
    v_or_b32 v84, v81, v83
    v_and_b32 v84, 0x0fffffff, v84
    v_or3_b32 v80, v80, v84, v82
    v_cmp_eq_u32 vcc, 0, v80
    s_nop 0
    s_cmp_eq_u64 vcc, -1
    s_nop 2
    s_cbranch_scc0 L_statpoll
L_statok:
    v_readfirstlane_b32 s83, v81
    s_nop 0
    s_lshr_b32 s83, s83, 28
    s_cmp_eq_u32 s83, s80
    s_cselect_b32 s60, 1, 0
    s_cselect_b32 s30, 16777216, 0
    s_cselect_b32 s38, 0, 16777216
    v_max_f32 v80, v14, v72
    v_max_f32 v81, v15, v76
    v_sub_f32 v82, v14, v80
    v_sub_f32 v84, v72, v80
    v_sub_f32 v83, v15, v81
    v_sub_f32 v85, v76, v81
    v_exp_f32 v82, v82
    v_exp_f32 v84, v84
    v_exp_f32 v83, v83
    v_exp_f32 v85, v85
    v_mul_f32 v84, v84, v73
    v_mul_f32 v85, v85, v77
    v_fma_f32 v84, v82, v11, v84
    v_fma_f32 v85, v83, v12, v85
    v_rcp_f32 v84, v84
    v_rcp_f32 v85, v85
    v_mul_f32 v11, v82, v84
    v_mul_f32 v12, v83, v85
    v_mov_b32 v103, s66
    v_mov_b32 v107, s66
    v_mov_b32 v111, s66
    s_waitcnt lgkmcnt(0)
    s_barrier
    ds_read_b128 v[192:195], v5 offset:0
    ds_read_b128 v[196:199], v5 offset:1024
    ds_read_b64_tr_b16 v[16:17], v6 offset:16384
    ds_read_b64_tr_b16 v[18:19], v6 offset:20480
    ds_read_b64_tr_b16 v[20:21], v7 offset:16384
    ds_read_b64_tr_b16 v[22:23], v7 offset:20480
    ds_read_b128 v[200:203], v5 offset:2048
    ds_read_b128 v[204:207], v5 offset:3072
    ds_read_b64_tr_b16 v[24:25], v6 offset:49152
    ds_read_b64_tr_b16 v[26:27], v6 offset:53248
    ds_read_b64_tr_b16 v[28:29], v7 offset:49152
    ds_read_b64_tr_b16 v[30:31], v7 offset:53248
    ds_read_b128 v[208:211], v5 offset:4096
    ds_read_b128 v[212:215], v5 offset:5120
    ds_read_b64_tr_b16 v[32:33], v8 offset:16384
    ds_read_b64_tr_b16 v[34:35], v8 offset:20480
    ds_read_b64_tr_b16 v[36:37], v9 offset:16384
    ds_read_b64_tr_b16 v[38:39], v9 offset:20480
    ds_read_b128 v[216:219], v5 offset:6144
    ds_read_b128 v[220:223], v5 offset:7168
    ds_read_b64_tr_b16 v[40:41], v8 offset:49152
    ds_read_b64_tr_b16 v[42:43], v8 offset:53248
    ds_read_b64_tr_b16 v[44:45], v9 offset:49152
    ds_read_b64_tr_b16 v[46:47], v9 offset:53248
    s_waitcnt lgkmcnt(15)
    v_mfma_f32_16x16x32_bf16 v[224:227], v[16:19], v[192:195], v[224:227]
    v_mfma_f32_16x16x32_bf16 v[232:235], v[16:19], v[196:199], v[232:235]
    v_mfma_f32_16x16x32_bf16 v[228:231], v[20:23], v[192:195], v[228:231]
    v_mfma_f32_16x16x32_bf16 v[236:239], v[20:23], v[196:199], v[236:239]
    s_waitcnt lgkmcnt(14)
    v_mfma_f32_16x16x32_bf16 v[224:227], v[24:27], v[200:203], v[224:227]
    v_mfma_f32_16x16x32_bf16 v[232:235], v[24:27], v[204:207], v[232:235]
    s_waitcnt lgkmcnt(12)
    v_mfma_f32_16x16x32_bf16 v[228:231], v[28:31], v[200:203], v[228:231]
    v_mfma_f32_16x16x32_bf16 v[236:239], v[28:31], v[204:207], v[236:239]
    s_waitcnt lgkmcnt(8)
    v_mfma_f32_16x16x32_bf16 v[224:227], v[32:35], v[208:211], v[224:227]
    v_mfma_f32_16x16x32_bf16 v[232:235], v[32:35], v[212:215], v[232:235]
    s_waitcnt lgkmcnt(6)
    v_mfma_f32_16x16x32_bf16 v[228:231], v[36:39], v[208:211], v[228:231]
    v_mfma_f32_16x16x32_bf16 v[236:239], v[36:39], v[212:215], v[236:239]
    s_waitcnt lgkmcnt(2)
    v_mfma_f32_16x16x32_bf16 v[224:227], v[40:43], v[216:219], v[224:227]
    v_mfma_f32_16x16x32_bf16 v[232:235], v[40:43], v[220:223], v[232:235]
    s_waitcnt lgkmcnt(0)
    v_mfma_f32_16x16x32_bf16 v[228:231], v[44:47], v[216:219], v[228:231]
    v_mfma_f32_16x16x32_bf16 v[236:239], v[44:47], v[220:223], v[236:239]
    ds_read_b128 v[192:195], v5 offset:8192
    ds_read_b128 v[196:199], v5 offset:9216
    ds_read_b128 v[200:203], v5 offset:10240
    ds_read_b128 v[204:207], v5 offset:11264
    ds_read_b128 v[208:211], v5 offset:12288
    ds_read_b128 v[212:215], v5 offset:13312
    ds_read_b128 v[216:219], v5 offset:14336
    ds_read_b128 v[220:223], v5 offset:15360
    s_waitcnt vmcnt(0)
    s_waitcnt lgkmcnt(0)
    s_barrier
    ds_read_b64_tr_b16 v[16:17], v6 offset:24576
    ds_read_b64_tr_b16 v[18:19], v6 offset:28672
    ds_read_b64_tr_b16 v[20:21], v7 offset:24576
    ds_read_b64_tr_b16 v[22:23], v7 offset:28672
    ds_read_b64_tr_b16 v[24:25], v6 offset:57344
    ds_read_b64_tr_b16 v[26:27], v6 offset:61440
    ds_read_b64_tr_b16 v[28:29], v7 offset:57344
    ds_read_b64_tr_b16 v[30:31], v7 offset:61440
    ds_read_b64_tr_b16 v[32:33], v8 offset:24576
    ds_read_b64_tr_b16 v[34:35], v8 offset:28672
    ds_read_b64_tr_b16 v[36:37], v9 offset:24576
    ds_read_b64_tr_b16 v[38:39], v9 offset:28672
    ds_read_b64_tr_b16 v[40:41], v8 offset:57344
    ds_read_b64_tr_b16 v[42:43], v8 offset:61440
    ds_read_b64_tr_b16 v[44:45], v9 offset:57344
    ds_read_b64_tr_b16 v[46:47], v9 offset:61440
    s_waitcnt lgkmcnt(14)
    v_mfma_f32_16x16x32_bf16 v[224:227], v[16:19], v[192:195], v[224:227]
    v_mfma_f32_16x16x32_bf16 v[232:235], v[16:19], v[196:199], v[232:235]
    s_waitcnt lgkmcnt(12)
    v_mfma_f32_16x16x32_bf16 v[228:231], v[20:23], v[192:195], v[228:231]
    v_mfma_f32_16x16x32_bf16 v[236:239], v[20:23], v[196:199], v[236:239]
    s_waitcnt lgkmcnt(10)
    v_mfma_f32_16x16x32_bf16 v[224:227], v[24:27], v[200:203], v[224:227]
    v_mfma_f32_16x16x32_bf16 v[232:235], v[24:27], v[204:207], v[232:235]
    s_waitcnt lgkmcnt(8)
    v_mfma_f32_16x16x32_bf16 v[228:231], v[28:31], v[200:203], v[228:231]
    v_mfma_f32_16x16x32_bf16 v[236:239], v[28:31], v[204:207], v[236:239]
    s_waitcnt lgkmcnt(6)
    v_mfma_f32_16x16x32_bf16 v[224:227], v[32:35], v[208:211], v[224:227]
    v_mfma_f32_16x16x32_bf16 v[232:235], v[32:35], v[212:215], v[232:235]
    s_waitcnt lgkmcnt(4)
    v_mfma_f32_16x16x32_bf16 v[228:231], v[36:39], v[208:211], v[228:231]
    v_mfma_f32_16x16x32_bf16 v[236:239], v[36:39], v[212:215], v[236:239]
    s_waitcnt lgkmcnt(2)
    v_mfma_f32_16x16x32_bf16 v[224:227], v[40:43], v[216:219], v[224:227]
    v_mfma_f32_16x16x32_bf16 v[232:235], v[40:43], v[220:223], v[232:235]
    s_waitcnt lgkmcnt(0)
    v_mfma_f32_16x16x32_bf16 v[228:231], v[44:47], v[216:219], v[228:231]
    v_mfma_f32_16x16x32_bf16 v[236:239], v[44:47], v[220:223], v[236:239]
    s_nop 3
    v_mul_f32 v224, v224, v11
    v_mul_f32 v225, v225, v11
    v_mul_f32 v226, v226, v11
    v_mul_f32 v227, v227, v11
    v_cvt_pk_bf16_f32 v100, v224, v225
    v_cvt_pk_bf16_f32 v101, v226, v227
    v_mul_f32 v228, v228, v11
    v_mul_f32 v229, v229, v11
    v_mul_f32 v230, v230, v11
    v_mul_f32 v231, v231, v11
    v_cvt_pk_bf16_f32 v102, v228, v229
    v_cvt_pk_bf16_f32 v104, v230, v231
    v_mul_f32 v232, v232, v12
    v_mul_f32 v233, v233, v12
    v_mul_f32 v234, v234, v12
    v_mul_f32 v235, v235, v12
    v_cvt_pk_bf16_f32 v105, v232, v233
    v_cvt_pk_bf16_f32 v106, v234, v235
    v_mul_f32 v236, v236, v12
    v_mul_f32 v237, v237, v12
    v_mul_f32 v238, v238, v12
    v_mul_f32 v239, v239, v12
    v_cvt_pk_bf16_f32 v108, v236, v237
    v_cvt_pk_bf16_f32 v109, v238, v239
    s_cmp_eq_u32 s60, 0
    s_cbranch_scc1 L_xfar
    buffer_store_dwordx4 v[100:103], v10, s[40:43], s77 offen offset:0
    buffer_store_dwordx4 v[104:107], v10, s[40:43], s77 offen offset:1024
    buffer_store_dwordx4 v[108:111], v10, s[40:43], s77 offen offset:2048
L_xsent:
    s_mov_b32 s82, 2000000
    s_nop 0
L_xp:
    buffer_load_dwordx4 v[112:115], v10, s[40:43], s78 offen offset:0 sc1
    buffer_load_dwordx4 v[116:119], v10, s[40:43], s78 offen offset:1024 sc1
    buffer_load_dwordx4 v[120:123], v10, s[40:43], s78 offen offset:2048 sc1
    s_waitcnt vmcnt(0)
    v_xor_b32 v70, s66, v115
    v_xor_b32 v71, s66, v119
    v_xor_b32 v72, s66, v123
    v_or3_b32 v70, v70, v71, v72
    v_cmp_eq_u32 vcc, 0, v70
    s_nop 0
    s_cmp_eq_u64 vcc, -1
    s_nop 2
    s_cbranch_scc1 L_xp_ok
    s_sub_u32 s82, s82, 1
    s_cmp_lg_u32 s82, 0
    s_cbranch_scc1 L_xp
    s_endpgm
L_xp_ok:
    v_lshlrev_b32 v16, 16, v112
    v_and_b32 v17, 0xffff0000, v112
    v_lshlrev_b32 v18, 16, v113
    v_and_b32 v19, 0xffff0000, v113
    v_lshlrev_b32 v20, 16, v114
    v_and_b32 v21, 0xffff0000, v114
    v_lshlrev_b32 v22, 16, v116
    v_and_b32 v23, 0xffff0000, v116
    v_add_f32 v16, v16, v224
    v_add_f32 v17, v17, v225
    v_add_f32 v18, v18, v226
    v_add_f32 v19, v19, v227
    v_add_f32 v20, v20, v228
    v_add_f32 v21, v21, v229
    v_add_f32 v22, v22, v230
    v_add_f32 v23, v23, v231
    v_cvt_pk_bf16_f32 v128, v16, v17
    v_cvt_pk_bf16_f32 v129, v18, v19
    v_cvt_pk_bf16_f32 v130, v20, v21
    v_cvt_pk_bf16_f32 v131, v22, v23
    ds_write_b128 v243, v[128:131] offset:0
    v_lshlrev_b32 v24, 16, v117
    v_and_b32 v25, 0xffff0000, v117
    v_mfma_f32_16x16x32_bf16 v[168:171], a[0:3], v[128:131], 0
    v_lshlrev_b32 v26, 16, v118
    v_and_b32 v27, 0xffff0000, v118
    v_lshlrev_b32 v28, 16, v120
    v_mfma_f32_16x16x32_bf16 v[172:175], a[4:7], v[128:131], 0
    v_and_b32 v29, 0xffff0000, v120
    v_lshlrev_b32 v30, 16, v121
    v_and_b32 v31, 0xffff0000, v121
    v_mfma_f32_16x16x32_bf16 v[176:179], a[8:11], v[128:131], 0
    v_add_f32 v24, v24, v232
    v_add_f32 v25, v25, v233
    v_add_f32 v26, v26, v234
    v_mfma_f32_16x16x32_bf16 v[180:183], a[12:15], v[128:131], 0
    v_add_f32 v27, v27, v235
    v_add_f32 v28, v28, v236
    v_add_f32 v29, v29, v237
    v_mfma_f32_16x16x32_bf16 v[184:187], a[16:19], v[128:131], 0
    v_add_f32 v30, v30, v238
    v_add_f32 v31, v31, v239
    v_cvt_pk_bf16_f32 v132, v24, v25
    v_mfma_f32_16x16x32_bf16 v[188:191], a[20:23], v[128:131], 0
    v_cvt_pk_bf16_f32 v133, v26, v27
    v_cvt_pk_bf16_f32 v134, v28, v29
    v_cvt_pk_bf16_f32 v135, v30, v31
    ds_write_b128 v243, v[132:135] offset:4096
    s_waitcnt lgkmcnt(0)
    s_barrier
    s_cmp_eq_u32 s3, 3
    s_cbranch_scc1 L_fin
    ds_read_b128 v[140:143], v244 offset:0
    ds_read_b128 v[156:159], v244 offset:4096
    ds_read_b128 v[144:147], v245 offset:0
    ds_read_b128 v[160:163], v245 offset:4096
    ds_read_b128 v[148:151], v246 offset:0
    ds_read_b128 v[164:167], v246 offset:4096
    v_mfma_f32_16x16x32_bf16 v[168:171], a[96:99], v[132:135], v[168:171]
    v_mfma_f32_16x16x32_bf16 v[172:175], a[100:103], v[132:135], v[172:175]
    v_mfma_f32_16x16x32_bf16 v[176:179], a[104:107], v[132:135], v[176:179]
    v_mfma_f32_16x16x32_bf16 v[180:183], a[108:111], v[132:135], v[180:183]
    v_mfma_f32_16x16x32_bf16 v[184:187], a[112:115], v[132:135], v[184:187]
    v_mfma_f32_16x16x32_bf16 v[188:191], a[116:119], v[132:135], v[188:191]
    v_mov_b32 v195, s66
    v_mov_b32 v199, s66
    v_mov_b32 v203, s66
    v_mov_b32 v207, s66
    s_waitcnt lgkmcnt(5)
    v_mfma_f32_16x16x32_bf16 v[168:171], a[24:27], v[140:143], v[168:171]
    v_mfma_f32_16x16x32_bf16 v[172:175], a[28:31], v[140:143], v[172:175]
    s_waitcnt lgkmcnt(4)
    v_mfma_f32_16x16x32_bf16 v[168:171], a[120:123], v[156:159], v[168:171]
    v_mfma_f32_16x16x32_bf16 v[172:175], a[124:127], v[156:159], v[172:175]
    s_waitcnt lgkmcnt(3)
    v_mfma_f32_16x16x32_bf16 v[168:171], a[48:51], v[144:147], v[168:171]
    v_mfma_f32_16x16x32_bf16 v[172:175], a[52:55], v[144:147], v[172:175]
    s_waitcnt lgkmcnt(2)
    v_mfma_f32_16x16x32_bf16 v[168:171], a[144:147], v[160:163], v[168:171]
    v_mfma_f32_16x16x32_bf16 v[172:175], a[148:151], v[160:163], v[172:175]
    s_waitcnt lgkmcnt(1)
    v_mfma_f32_16x16x32_bf16 v[168:171], a[72:75], v[148:151], v[168:171]
    v_mfma_f32_16x16x32_bf16 v[172:175], a[76:79], v[148:151], v[172:175]
    s_waitcnt lgkmcnt(0)
    v_mfma_f32_16x16x32_bf16 v[168:171], a[168:171], v[164:167], v[168:171]
    v_mfma_f32_16x16x32_bf16 v[172:175], a[172:175], v[164:167], v[172:175]
    v_mfma_f32_16x16x32_bf16 v[176:179], a[32:35], v[140:143], v[176:179]
    v_mfma_f32_16x16x32_bf16 v[180:183], a[36:39], v[140:143], v[180:183]
    v_mfma_f32_16x16x32_bf16 v[176:179], a[128:131], v[156:159], v[176:179]
    v_mfma_f32_16x16x32_bf16 v[180:183], a[132:135], v[156:159], v[180:183]
    v_mfma_f32_16x16x32_bf16 v[176:179], a[56:59], v[144:147], v[176:179]
    v_mfma_f32_16x16x32_bf16 v[180:183], a[60:63], v[144:147], v[180:183]
    v_mfma_f32_16x16x32_bf16 v[176:179], a[152:155], v[160:163], v[176:179]
    v_mfma_f32_16x16x32_bf16 v[180:183], a[156:159], v[160:163], v[180:183]
    v_mfma_f32_16x16x32_bf16 v[176:179], a[80:83], v[148:151], v[176:179]
    v_mfma_f32_16x16x32_bf16 v[180:183], a[84:87], v[148:151], v[180:183]
    v_cvt_pk_bf16_f32 v192, v168, v172
    v_cvt_pk_bf16_f32 v193, v169, v173
    v_cvt_pk_bf16_f32 v194, v170, v174
    v_cvt_pk_bf16_f32 v196, v171, v175
    buffer_store_dwordx4 v[192:195], v240, s[40:43], s4 offen offset:0 sc1
    v_mfma_f32_16x16x32_bf16 v[176:179], a[176:179], v[164:167], v[176:179]
    v_mfma_f32_16x16x32_bf16 v[180:183], a[180:183], v[164:167], v[180:183]
    v_mfma_f32_16x16x32_bf16 v[184:187], a[40:43], v[140:143], v[184:187]
    v_mfma_f32_16x16x32_bf16 v[188:191], a[44:47], v[140:143], v[188:191]
    v_mfma_f32_16x16x32_bf16 v[184:187], a[136:139], v[156:159], v[184:187]
    v_mfma_f32_16x16x32_bf16 v[188:191], a[140:143], v[156:159], v[188:191]
    v_mfma_f32_16x16x32_bf16 v[184:187], a[64:67], v[144:147], v[184:187]
    v_mfma_f32_16x16x32_bf16 v[188:191], a[68:71], v[144:147], v[188:191]
    v_mfma_f32_16x16x32_bf16 v[184:187], a[160:163], v[160:163], v[184:187]
    v_mfma_f32_16x16x32_bf16 v[188:191], a[164:167], v[160:163], v[188:191]
    v_mfma_f32_16x16x32_bf16 v[184:187], a[88:91], v[148:151], v[184:187]
    v_mfma_f32_16x16x32_bf16 v[188:191], a[92:95], v[148:151], v[188:191]
    v_cvt_pk_bf16_f32 v197, v176, v180
    v_cvt_pk_bf16_f32 v198, v177, v181
    v_cvt_pk_bf16_f32 v200, v178, v182
    v_cvt_pk_bf16_f32 v201, v179, v183
    buffer_store_dwordx4 v[196:199], v240, s[40:43], s4 offen offset:64 sc1
    v_mfma_f32_16x16x32_bf16 v[184:187], a[184:187], v[164:167], v[184:187]
    v_mfma_f32_16x16x32_bf16 v[188:191], a[188:191], v[164:167], v[188:191]
    s_nop 7
    v_cvt_pk_bf16_f32 v202, v184, v188
    v_cvt_pk_bf16_f32 v204, v185, v189
    v_cvt_pk_bf16_f32 v205, v186, v190
    v_cvt_pk_bf16_f32 v206, v187, v191
    buffer_store_dwordx4 v[200:203], v240, s[40:43], s4 offen offset:128 sc1
    buffer_store_dwordx4 v[204:207], v240, s[40:43], s4 offen offset:192 sc1
    s_waitcnt vmcnt(0)
    s_mov_b32 s82, 2000000
L_gp:
    buffer_load_dwordx4 v[208:211], v242, s[40:43], s6 offen offset:0 sc1
    buffer_load_dwordx4 v[212:215], v242, s[40:43], s6 offen offset:3072 sc1
    buffer_load_dwordx4 v[216:219], v242, s[40:43], s7 offen offset:0 sc1
    buffer_load_dwordx4 v[220:223], v242, s[40:43], s7 offen offset:3072 sc1
    s_waitcnt vmcnt(0)
    v_xor_b32 v70, s66, v211
    v_xor_b32 v71, s66, v215
    v_xor_b32 v72, s66, v219
    v_xor_b32 v73, s66, v223
    v_or3_b32 v70, v70, v71, v72
    v_or_b32 v70, v70, v73
    v_cmp_eq_u32 vcc, 0, v70
    s_nop 0
    s_cmp_eq_u64 vcc, -1
    s_nop 2
    s_cbranch_scc1 L_gp_ok
    s_sub_u32 s82, s82, 1
    s_cmp_lg_u32 s82, 0
    s_cbranch_scc1 L_gp
    s_endpgm
L_gp_ok:
    v_lshlrev_b32 v16, 16, v208
    v_and_b32 v20, 0xffff0000, v208
    v_lshlrev_b32 v17, 16, v209
    v_and_b32 v21, 0xffff0000, v209
    v_lshlrev_b32 v18, 16, v210
    v_and_b32 v22, 0xffff0000, v210
    v_lshlrev_b32 v24, 16, v212
    v_and_b32 v28, 0xffff0000, v212
    v_lshlrev_b32 v25, 16, v213
    v_and_b32 v29, 0xffff0000, v213
    v_lshlrev_b32 v26, 16, v214
    v_and_b32 v30, 0xffff0000, v214
    v_lshlrev_b32 v32, 16, v216
    v_and_b32 v36, 0xffff0000, v216
    v_lshlrev_b32 v33, 16, v217
    v_and_b32 v37, 0xffff0000, v217
    v_lshlrev_b32 v34, 16, v218
    v_and_b32 v38, 0xffff0000, v218
    v_lshlrev_b32 v40, 16, v220
    v_and_b32 v44, 0xffff0000, v220
    v_lshlrev_b32 v41, 16, v221
    v_and_b32 v45, 0xffff0000, v221
    v_lshlrev_b32 v42, 16, v222
    v_and_b32 v46, 0xffff0000, v222
    v_add_f32 v16, v16, v24
    v_add_f32 v32, v32, v40
    v_add_f32 v17, v17, v25
    v_add_f32 v33, v33, v41
    v_add_f32 v18, v18, v26
    v_add_f32 v34, v34, v42
    v_add_f32 v20, v20, v28
    v_add_f32 v36, v36, v44
    v_add_f32 v21, v21, v29
    v_add_f32 v37, v37, v45
    v_add_f32 v22, v22, v30
    v_add_f32 v38, v38, v46
    v_add_f32 v17, v17, v33
    v_add_f32 v21, v21, v37
    v_add_f32 v16, v16, v32
    v_add_f32 v20, v20, v36
    v_add_f32 v18, v18, v34
    v_add_f32 v22, v22, v38
    v_mov_b32 v19, v17
    v_mov_b32 v23, v21
    v_permlane32_swap_b32 v16, v18
    v_permlane32_swap_b32 v20, v22
    v_permlane32_swap_b32 v17, v19
    v_permlane32_swap_b32 v21, v23
    v_add_f32 v16, v16, v18
    v_add_f32 v20, v20, v22
    v_add_f32 v17, v17, v19
    v_add_f32 v21, v21, v23
    s_nop 0
    v_permlane16_swap_b32 v16, v17
    v_permlane16_swap_b32 v20, v21
    v_add_f32 v16, v16, v17
    v_add_f32 v20, v20, v21
    v_cvt_pk_bf16_f32 v16, v16, v20
    buffer_store_dword v16, v241, s[44:47], s8 offen
    s_or_b32 s83, s63, s64
    s_or_b32 s83, s83, s3
    s_cmp_lg_u32 s83, 0
    s_cbranch_scc1 L_noep
    v_mov_b32 v1, s66
    s_lshl_b32 s83, s65, 8
    v_mov_b32 v2, 12
    buffer_store_dword v1, v2, s[40:43], s83 offen
    s_nop 1
L_noep:
L_fin:
L_end:
    s_endpgm
L_xfar:
    buffer_store_dwordx4 v[100:103], v10, s[40:43], s77 offen offset:0 sc1
    buffer_store_dwordx4 v[104:107], v10, s[40:43], s77 offen offset:1024 sc1
    buffer_store_dwordx4 v[108:111], v10, s[40:43], s77 offen offset:2048 sc1
    s_branch L_xsent
L_QB:
    s_mov_b32 s61, 0
    buffer_load_dwordx4 v[192:195], v11, s[28:31], s61 offen
    s_mov_b32 s61, 8192
    buffer_load_dwordx4 v[196:199], v11, s[28:31], s61 offen
    s_mov_b32 s61, 16384
    buffer_load_dwordx4 v[200:203], v11, s[28:31], s61 offen
    s_mov_b32 s61, 24576
    buffer_load_dwordx4 v[204:207], v11, s[28:31], s61 offen
    s_mov_b32 s61, 32768
    buffer_load_dwordx4 v[208:211], v11, s[28:31], s61 offen
    s_mov_b32 s61, 40960
    buffer_load_dwordx4 v[212:215], v11, s[28:31], s61 offen
    s_mov_b32 s61, 49152
    buffer_load_dwordx4 v[216:219], v11, s[28:31], s61 offen
    s_mov_b32 s61, 57344
    buffer_load_dwordx4 v[220:223], v11, s[28:31], s61 offen
    s_mov_b32 s61, 262144
    buffer_load_dwordx4 v[224:227], v11, s[28:31], s61 offen
    s_mov_b32 s61, 270336
    buffer_load_dwordx4 v[228:231], v11, s[28:31], s61 offen
    s_mov_b32 s61, 278528
    buffer_load_dwordx4 v[232:235], v11, s[28:31], s61 offen
    s_mov_b32 s61, 286720
    buffer_load_dwordx4 v[236:239], v11, s[28:31], s61 offen
    s_mov_b32 s61, 294912
    buffer_load_dwordx4 v[240:243], v11, s[28:31], s61 offen
    s_mov_b32 s61, 303104
    buffer_load_dwordx4 v[244:247], v11, s[28:31], s61 offen
    s_mov_b32 s61, 311296
    buffer_load_dwordx4 v[248:251], v11, s[28:31], s61 offen
    s_mov_b32 s61, 319488
    buffer_load_dwordx4 v[252:255], v11, s[28:31], s61 offen
    s_waitcnt vmcnt(15)
    s_barrier
    ds_read_b128 v[48:51], v12 offset:0
    ds_read_b128 v[52:55], v12 offset:64
    ds_read_b128 v[56:59], v12 offset:128
    ds_read_b128 v[60:63], v12 offset:192
    ds_read_b128 v[64:67], v12 offset:256
    ds_read_b128 v[68:71], v12 offset:320
    ds_read_b128 v[72:75], v12 offset:384
    ds_read_b128 v[76:79], v12 offset:448
    ds_read_b128 v[80:83], v12 offset:512
    s_mov_b32 s61, 524288
    buffer_load_dwordx4 v[116:119], v11, s[28:31], s61 offen
    s_waitcnt vmcnt(9)
    s_waitcnt lgkmcnt(8)
    v_perm_b32 v176, v196, v192, s48
    v_perm_b32 v177, v204, v200, s48
    v_perm_b32 v178, v212, v208, s48
    v_perm_b32 v179, v220, v216, s48
    v_perm_b32 v180, v196, v192, s49
    v_perm_b32 v181, v204, v200, s49
    v_perm_b32 v182, v212, v208, s49
    s_mov_b32 s61, 532480
    buffer_load_dwordx4 v[120:123], v11, s[28:31], s61 offen
    v_perm_b32 v183, v220, v216, s49
    v_mfma_f32_16x16x32_bf16 v[84:87], v[176:179], v[48:51], 0
    s_nop 0
    v_mfma_f32_16x16x32_bf16 v[88:91], v[180:183], v[48:51], 0
    s_mov_b32 s61, 540672
    buffer_load_dwordx4 v[124:127], v11, s[28:31], s61 offen
    v_perm_b32 v184, v197, v193, s48
    v_perm_b32 v185, v205, v201, s48
    v_perm_b32 v186, v213, v209, s48
    v_perm_b32 v187, v221, v217, s48
    v_perm_b32 v188, v197, v193, s49
    v_perm_b32 v189, v205, v201, s49
    v_perm_b32 v190, v213, v209, s49
    s_mov_b32 s61, 548864
    buffer_load_dwordx4 v[128:131], v11, s[28:31], s61 offen
    v_perm_b32 v191, v221, v217, s49
    v_mfma_f32_16x16x32_bf16 v[92:95], v[184:187], v[48:51], 0
    s_nop 0
    v_mfma_f32_16x16x32_bf16 v[96:99], v[188:191], v[48:51], 0
    s_mov_b32 s61, 557056
    buffer_load_dwordx4 v[132:135], v11, s[28:31], s61 offen
    v_perm_b32 v176, v198, v194, s48
    v_perm_b32 v177, v206, v202, s48
    v_perm_b32 v178, v214, v210, s48
    v_perm_b32 v179, v222, v218, s48
    v_perm_b32 v180, v198, v194, s49
    v_perm_b32 v181, v206, v202, s49
    v_perm_b32 v182, v214, v210, s49
    s_mov_b32 s61, 565248
    buffer_load_dwordx4 v[136:139], v11, s[28:31], s61 offen
    v_perm_b32 v183, v222, v218, s49
    v_mfma_f32_16x16x32_bf16 v[100:103], v[176:179], v[48:51], 0
    s_nop 0
    v_mfma_f32_16x16x32_bf16 v[104:107], v[180:183], v[48:51], 0
    s_mov_b32 s61, 573440
    buffer_load_dwordx4 v[140:143], v11, s[28:31], s61 offen
    v_perm_b32 v184, v199, v195, s48
    v_perm_b32 v185, v207, v203, s48
    v_perm_b32 v186, v215, v211, s48
    v_perm_b32 v187, v223, v219, s48
    v_perm_b32 v188, v199, v195, s49
    v_perm_b32 v189, v207, v203, s49
    v_perm_b32 v190, v215, v211, s49
    s_mov_b32 s61, 581632
    buffer_load_dwordx4 v[144:147], v11, s[28:31], s61 offen
    v_perm_b32 v191, v223, v219, s49
    v_mfma_f32_16x16x32_bf16 v[108:111], v[184:187], v[48:51], 0
    s_nop 0
    v_mfma_f32_16x16x32_bf16 v[112:115], v[188:191], v[48:51], 0
    s_waitcnt vmcnt(15)
    s_mov_b32 s61, 786432
    buffer_load_dwordx4 v[192:195], v11, s[28:31], s61 offen
    s_waitcnt vmcnt(9)
    s_waitcnt lgkmcnt(7)
    v_perm_b32 v176, v228, v224, s48
    v_perm_b32 v177, v236, v232, s48
    v_perm_b32 v178, v244, v240, s48
    v_perm_b32 v179, v252, v248, s48
    v_perm_b32 v180, v228, v224, s49
    v_perm_b32 v181, v236, v232, s49
    v_perm_b32 v182, v244, v240, s49
    s_mov_b32 s61, 794624
    buffer_load_dwordx4 v[196:199], v11, s[28:31], s61 offen
    v_perm_b32 v183, v252, v248, s49
    v_mfma_f32_16x16x32_bf16 v[84:87], v[176:179], v[52:55], v[84:87]
    s_nop 0
    v_mfma_f32_16x16x32_bf16 v[88:91], v[180:183], v[52:55], v[88:91]
    s_mov_b32 s61, 802816
    buffer_load_dwordx4 v[200:203], v11, s[28:31], s61 offen
    v_perm_b32 v184, v229, v225, s48
    v_perm_b32 v185, v237, v233, s48
    v_perm_b32 v186, v245, v241, s48
    v_perm_b32 v187, v253, v249, s48
    v_perm_b32 v188, v229, v225, s49
    v_perm_b32 v189, v237, v233, s49
    v_perm_b32 v190, v245, v241, s49
    s_mov_b32 s61, 811008
    buffer_load_dwordx4 v[204:207], v11, s[28:31], s61 offen
    v_perm_b32 v191, v253, v249, s49
    v_mfma_f32_16x16x32_bf16 v[92:95], v[184:187], v[52:55], v[92:95]
    s_nop 0
    v_mfma_f32_16x16x32_bf16 v[96:99], v[188:191], v[52:55], v[96:99]
    s_mov_b32 s61, 819200
    buffer_load_dwordx4 v[208:211], v11, s[28:31], s61 offen
    v_perm_b32 v176, v230, v226, s48
    v_perm_b32 v177, v238, v234, s48
    v_perm_b32 v178, v246, v242, s48
    v_perm_b32 v179, v254, v250, s48
    v_perm_b32 v180, v230, v226, s49
    v_perm_b32 v181, v238, v234, s49
    v_perm_b32 v182, v246, v242, s49
    s_mov_b32 s61, 827392
    buffer_load_dwordx4 v[212:215], v11, s[28:31], s61 offen
    v_perm_b32 v183, v254, v250, s49
    v_mfma_f32_16x16x32_bf16 v[100:103], v[176:179], v[52:55], v[100:103]
    s_nop 0
    v_mfma_f32_16x16x32_bf16 v[104:107], v[180:183], v[52:55], v[104:107]
    s_mov_b32 s61, 835584
    buffer_load_dwordx4 v[216:219], v11, s[28:31], s61 offen
    v_perm_b32 v184, v231, v227, s48
    v_perm_b32 v185, v239, v235, s48
    v_perm_b32 v186, v247, v243, s48
    v_perm_b32 v187, v255, v251, s48
    v_perm_b32 v188, v231, v227, s49
    v_perm_b32 v189, v239, v235, s49
    v_perm_b32 v190, v247, v243, s49
    s_mov_b32 s61, 843776
    buffer_load_dwordx4 v[220:223], v11, s[28:31], s61 offen
    v_perm_b32 v191, v255, v251, s49
    v_mfma_f32_16x16x32_bf16 v[108:111], v[184:187], v[52:55], v[108:111]
    s_nop 0
    v_mfma_f32_16x16x32_bf16 v[112:115], v[188:191], v[52:55], v[112:115]
    s_waitcnt vmcnt(15)
    s_mov_b32 s61, 1048576
    buffer_load_dwordx4 v[224:227], v11, s[28:31], s61 offen
    s_waitcnt vmcnt(9)
    s_waitcnt lgkmcnt(6)
    v_perm_b32 v176, v120, v116, s48
    v_perm_b32 v177, v128, v124, s48
    v_perm_b32 v178, v136, v132, s48
    v_perm_b32 v179, v144, v140, s48
    v_perm_b32 v180, v120, v116, s49
    v_perm_b32 v181, v128, v124, s49
    v_perm_b32 v182, v136, v132, s49
    s_mov_b32 s61, 1056768
    buffer_load_dwordx4 v[228:231], v11, s[28:31], s61 offen
    v_perm_b32 v183, v144, v140, s49
    v_mfma_f32_16x16x32_bf16 v[84:87], v[176:179], v[56:59], v[84:87]
    s_nop 0
    v_mfma_f32_16x16x32_bf16 v[88:91], v[180:183], v[56:59], v[88:91]
    s_mov_b32 s61, 1064960
    buffer_load_dwordx4 v[232:235], v11, s[28:31], s61 offen
    v_perm_b32 v184, v121, v117, s48
    v_perm_b32 v185, v129, v125, s48
    v_perm_b32 v186, v137, v133, s48
    v_perm_b32 v187, v145, v141, s48
    v_perm_b32 v188, v121, v117, s49
    v_perm_b32 v189, v129, v125, s49
    v_perm_b32 v190, v137, v133, s49
    s_mov_b32 s61, 1073152
    buffer_load_dwordx4 v[236:239], v11, s[28:31], s61 offen
    v_perm_b32 v191, v145, v141, s49
    v_mfma_f32_16x16x32_bf16 v[92:95], v[184:187], v[56:59], v[92:95]
    s_nop 0
    v_mfma_f32_16x16x32_bf16 v[96:99], v[188:191], v[56:59], v[96:99]
    s_mov_b32 s61, 1081344
    buffer_load_dwordx4 v[240:243], v11, s[28:31], s61 offen
    v_perm_b32 v176, v122, v118, s48
    v_perm_b32 v177, v130, v126, s48
    v_perm_b32 v178, v138, v134, s48
    v_perm_b32 v179, v146, v142, s48
    v_perm_b32 v180, v122, v118, s49
    v_perm_b32 v181, v130, v126, s49
    v_perm_b32 v182, v138, v134, s49
    s_mov_b32 s61, 1089536
    buffer_load_dwordx4 v[244:247], v11, s[28:31], s61 offen
    v_perm_b32 v183, v146, v142, s49
    v_mfma_f32_16x16x32_bf16 v[100:103], v[176:179], v[56:59], v[100:103]
    s_nop 0
    v_mfma_f32_16x16x32_bf16 v[104:107], v[180:183], v[56:59], v[104:107]
    s_mov_b32 s61, 1097728
    buffer_load_dwordx4 v[248:251], v11, s[28:31], s61 offen
    v_perm_b32 v184, v123, v119, s48
    v_perm_b32 v185, v131, v127, s48
    v_perm_b32 v186, v139, v135, s48
    v_perm_b32 v187, v147, v143, s48
    v_perm_b32 v188, v123, v119, s49
    v_perm_b32 v189, v131, v127, s49
    v_perm_b32 v190, v139, v135, s49
    s_mov_b32 s61, 1105920
    buffer_load_dwordx4 v[252:255], v11, s[28:31], s61 offen
    v_perm_b32 v191, v147, v143, s49
    v_mfma_f32_16x16x32_bf16 v[108:111], v[184:187], v[56:59], v[108:111]
    s_nop 0
    v_mfma_f32_16x16x32_bf16 v[112:115], v[188:191], v[56:59], v[112:115]
    s_waitcnt vmcnt(15)
    s_mov_b32 s61, 1310720
    buffer_load_dwordx4 v[116:119], v11, s[28:31], s61 offen
    s_waitcnt vmcnt(9)
    s_waitcnt lgkmcnt(5)
    v_perm_b32 v176, v196, v192, s48
    v_perm_b32 v177, v204, v200, s48
    v_perm_b32 v178, v212, v208, s48
    v_perm_b32 v179, v220, v216, s48
    v_perm_b32 v180, v196, v192, s49
    v_perm_b32 v181, v204, v200, s49
    v_perm_b32 v182, v212, v208, s49
    s_mov_b32 s61, 1318912
    buffer_load_dwordx4 v[120:123], v11, s[28:31], s61 offen
    v_perm_b32 v183, v220, v216, s49
    v_mfma_f32_16x16x32_bf16 v[84:87], v[176:179], v[60:63], v[84:87]
    s_nop 0
    v_mfma_f32_16x16x32_bf16 v[88:91], v[180:183], v[60:63], v[88:91]
    s_mov_b32 s61, 1327104
    buffer_load_dwordx4 v[124:127], v11, s[28:31], s61 offen
    v_perm_b32 v184, v197, v193, s48
    v_perm_b32 v185, v205, v201, s48
    v_perm_b32 v186, v213, v209, s48
    v_perm_b32 v187, v221, v217, s48
    v_perm_b32 v188, v197, v193, s49
    v_perm_b32 v189, v205, v201, s49
    v_perm_b32 v190, v213, v209, s49
    s_mov_b32 s61, 1335296
    buffer_load_dwordx4 v[128:131], v11, s[28:31], s61 offen
    v_perm_b32 v191, v221, v217, s49
    v_mfma_f32_16x16x32_bf16 v[92:95], v[184:187], v[60:63], v[92:95]
    s_nop 0
    v_mfma_f32_16x16x32_bf16 v[96:99], v[188:191], v[60:63], v[96:99]
    s_mov_b32 s61, 1343488
    buffer_load_dwordx4 v[132:135], v11, s[28:31], s61 offen
    v_perm_b32 v176, v198, v194, s48
    v_perm_b32 v177, v206, v202, s48
    v_perm_b32 v178, v214, v210, s48
    v_perm_b32 v179, v222, v218, s48
    v_perm_b32 v180, v198, v194, s49
    v_perm_b32 v181, v206, v202, s49
    v_perm_b32 v182, v214, v210, s49
    s_mov_b32 s61, 1351680
    buffer_load_dwordx4 v[136:139], v11, s[28:31], s61 offen
    v_perm_b32 v183, v222, v218, s49
    v_mfma_f32_16x16x32_bf16 v[100:103], v[176:179], v[60:63], v[100:103]
    s_nop 0
    v_mfma_f32_16x16x32_bf16 v[104:107], v[180:183], v[60:63], v[104:107]
    s_mov_b32 s61, 1359872
    buffer_load_dwordx4 v[140:143], v11, s[28:31], s61 offen
    v_perm_b32 v184, v199, v195, s48
    v_perm_b32 v185, v207, v203, s48
    v_perm_b32 v186, v215, v211, s48
    v_perm_b32 v187, v223, v219, s48
    v_perm_b32 v188, v199, v195, s49
    v_perm_b32 v189, v207, v203, s49
    v_perm_b32 v190, v215, v211, s49
    s_mov_b32 s61, 1368064
    buffer_load_dwordx4 v[144:147], v11, s[28:31], s61 offen
    v_perm_b32 v191, v223, v219, s49
    v_mfma_f32_16x16x32_bf16 v[108:111], v[184:187], v[60:63], v[108:111]
    s_nop 0
    v_mfma_f32_16x16x32_bf16 v[112:115], v[188:191], v[60:63], v[112:115]
    s_waitcnt vmcnt(15)
    s_mov_b32 s61, 1572864
    buffer_load_dwordx4 v[192:195], v11, s[28:31], s61 offen
    s_waitcnt vmcnt(9)
    s_waitcnt lgkmcnt(4)
    v_perm_b32 v176, v228, v224, s48
    v_perm_b32 v177, v236, v232, s48
    v_perm_b32 v178, v244, v240, s48
    v_perm_b32 v179, v252, v248, s48
    v_perm_b32 v180, v228, v224, s49
    v_perm_b32 v181, v236, v232, s49
    v_perm_b32 v182, v244, v240, s49
    s_mov_b32 s61, 1581056
    buffer_load_dwordx4 v[196:199], v11, s[28:31], s61 offen
    v_perm_b32 v183, v252, v248, s49
    v_mfma_f32_16x16x32_bf16 v[84:87], v[176:179], v[64:67], v[84:87]
    s_nop 0
    v_mfma_f32_16x16x32_bf16 v[88:91], v[180:183], v[64:67], v[88:91]
    s_mov_b32 s61, 1589248
    buffer_load_dwordx4 v[200:203], v11, s[28:31], s61 offen
    v_perm_b32 v184, v229, v225, s48
    v_perm_b32 v185, v237, v233, s48
    v_perm_b32 v186, v245, v241, s48
    v_perm_b32 v187, v253, v249, s48
    v_perm_b32 v188, v229, v225, s49
    v_perm_b32 v189, v237, v233, s49
    v_perm_b32 v190, v245, v241, s49
    s_mov_b32 s61, 1597440
    buffer_load_dwordx4 v[204:207], v11, s[28:31], s61 offen
    v_perm_b32 v191, v253, v249, s49
    v_mfma_f32_16x16x32_bf16 v[92:95], v[184:187], v[64:67], v[92:95]
    s_nop 0
    v_mfma_f32_16x16x32_bf16 v[96:99], v[188:191], v[64:67], v[96:99]
    s_mov_b32 s61, 1605632
    buffer_load_dwordx4 v[208:211], v11, s[28:31], s61 offen
    v_perm_b32 v176, v230, v226, s48
    v_perm_b32 v177, v238, v234, s48
    v_perm_b32 v178, v246, v242, s48
    v_perm_b32 v179, v254, v250, s48
    v_perm_b32 v180, v230, v226, s49
    v_perm_b32 v181, v238, v234, s49
    v_perm_b32 v182, v246, v242, s49
    s_mov_b32 s61, 1613824
    buffer_load_dwordx4 v[212:215], v11, s[28:31], s61 offen
    v_perm_b32 v183, v254, v250, s49
    v_mfma_f32_16x16x32_bf16 v[100:103], v[176:179], v[64:67], v[100:103]
    s_nop 0
    v_mfma_f32_16x16x32_bf16 v[104:107], v[180:183], v[64:67], v[104:107]
    s_mov_b32 s61, 1622016
    buffer_load_dwordx4 v[216:219], v11, s[28:31], s61 offen
    v_perm_b32 v184, v231, v227, s48
    v_perm_b32 v185, v239, v235, s48
    v_perm_b32 v186, v247, v243, s48
    v_perm_b32 v187, v255, v251, s48
    v_perm_b32 v188, v231, v227, s49
    v_perm_b32 v189, v239, v235, s49
    v_perm_b32 v190, v247, v243, s49
    s_mov_b32 s61, 1630208
    buffer_load_dwordx4 v[220:223], v11, s[28:31], s61 offen
    v_perm_b32 v191, v255, v251, s49
    v_mfma_f32_16x16x32_bf16 v[108:111], v[184:187], v[64:67], v[108:111]
    s_nop 0
    v_mfma_f32_16x16x32_bf16 v[112:115], v[188:191], v[64:67], v[112:115]
    s_waitcnt vmcnt(15)
    s_mov_b32 s61, 1835008
    buffer_load_dwordx4 v[224:227], v11, s[28:31], s61 offen
    s_waitcnt vmcnt(9)
    s_waitcnt lgkmcnt(3)
    v_perm_b32 v176, v120, v116, s48
    v_perm_b32 v177, v128, v124, s48
    v_perm_b32 v178, v136, v132, s48
    v_perm_b32 v179, v144, v140, s48
    v_perm_b32 v180, v120, v116, s49
    v_perm_b32 v181, v128, v124, s49
    v_perm_b32 v182, v136, v132, s49
    s_mov_b32 s61, 1843200
    buffer_load_dwordx4 v[228:231], v11, s[28:31], s61 offen
    v_perm_b32 v183, v144, v140, s49
    v_mfma_f32_16x16x32_bf16 v[84:87], v[176:179], v[68:71], v[84:87]
    s_nop 0
    v_mfma_f32_16x16x32_bf16 v[88:91], v[180:183], v[68:71], v[88:91]
    s_mov_b32 s61, 1851392
    buffer_load_dwordx4 v[232:235], v11, s[28:31], s61 offen
    v_perm_b32 v184, v121, v117, s48
    v_perm_b32 v185, v129, v125, s48
    v_perm_b32 v186, v137, v133, s48
    v_perm_b32 v187, v145, v141, s48
    v_perm_b32 v188, v121, v117, s49
    v_perm_b32 v189, v129, v125, s49
    v_perm_b32 v190, v137, v133, s49
    s_mov_b32 s61, 1859584
    buffer_load_dwordx4 v[236:239], v11, s[28:31], s61 offen
    v_perm_b32 v191, v145, v141, s49
    v_mfma_f32_16x16x32_bf16 v[92:95], v[184:187], v[68:71], v[92:95]
    s_nop 0
    v_mfma_f32_16x16x32_bf16 v[96:99], v[188:191], v[68:71], v[96:99]
    s_mov_b32 s61, 1867776
    buffer_load_dwordx4 v[240:243], v11, s[28:31], s61 offen
    v_perm_b32 v176, v122, v118, s48
    v_perm_b32 v177, v130, v126, s48
    v_perm_b32 v178, v138, v134, s48
    v_perm_b32 v179, v146, v142, s48
    v_perm_b32 v180, v122, v118, s49
    v_perm_b32 v181, v130, v126, s49
    v_perm_b32 v182, v138, v134, s49
    s_mov_b32 s61, 1875968
    buffer_load_dwordx4 v[244:247], v11, s[28:31], s61 offen
    v_perm_b32 v183, v146, v142, s49
    v_mfma_f32_16x16x32_bf16 v[100:103], v[176:179], v[68:71], v[100:103]
    s_nop 0
    v_mfma_f32_16x16x32_bf16 v[104:107], v[180:183], v[68:71], v[104:107]
    s_mov_b32 s61, 1884160
    buffer_load_dwordx4 v[248:251], v11, s[28:31], s61 offen
    v_perm_b32 v184, v123, v119, s48
    v_perm_b32 v185, v131, v127, s48
    v_perm_b32 v186, v139, v135, s48
    v_perm_b32 v187, v147, v143, s48
    v_perm_b32 v188, v123, v119, s49
    v_perm_b32 v189, v131, v127, s49
    v_perm_b32 v190, v139, v135, s49
    s_mov_b32 s61, 1892352
    buffer_load_dwordx4 v[252:255], v11, s[28:31], s61 offen
    v_perm_b32 v191, v147, v143, s49
    v_mfma_f32_16x16x32_bf16 v[108:111], v[184:187], v[68:71], v[108:111]
    s_nop 0
    v_mfma_f32_16x16x32_bf16 v[112:115], v[188:191], v[68:71], v[112:115]
    s_waitcnt vmcnt(15)
    s_mov_b32 s61, 2097152
    buffer_load_dwordx4 v[116:119], v11, s[28:31], s61 offen
    s_waitcnt vmcnt(9)
    s_waitcnt lgkmcnt(2)
    v_perm_b32 v176, v196, v192, s48
    v_perm_b32 v177, v204, v200, s48
    v_perm_b32 v178, v212, v208, s48
    v_perm_b32 v179, v220, v216, s48
    v_perm_b32 v180, v196, v192, s49
    v_perm_b32 v181, v204, v200, s49
    v_perm_b32 v182, v212, v208, s49
    s_mov_b32 s61, 2105344
    buffer_load_dwordx4 v[120:123], v11, s[28:31], s61 offen
    v_perm_b32 v183, v220, v216, s49
    v_mfma_f32_16x16x32_bf16 v[84:87], v[176:179], v[72:75], v[84:87]
    s_nop 0
    v_mfma_f32_16x16x32_bf16 v[88:91], v[180:183], v[72:75], v[88:91]
    s_mov_b32 s61, 2113536
    buffer_load_dwordx4 v[124:127], v11, s[28:31], s61 offen
    v_perm_b32 v184, v197, v193, s48
    v_perm_b32 v185, v205, v201, s48
    v_perm_b32 v186, v213, v209, s48
    v_perm_b32 v187, v221, v217, s48
    v_perm_b32 v188, v197, v193, s49
    v_perm_b32 v189, v205, v201, s49
    v_perm_b32 v190, v213, v209, s49
    s_mov_b32 s61, 2121728
    buffer_load_dwordx4 v[128:131], v11, s[28:31], s61 offen
    v_perm_b32 v191, v221, v217, s49
    v_mfma_f32_16x16x32_bf16 v[92:95], v[184:187], v[72:75], v[92:95]
    s_nop 0
    v_mfma_f32_16x16x32_bf16 v[96:99], v[188:191], v[72:75], v[96:99]
    s_mov_b32 s61, 2129920
    buffer_load_dwordx4 v[132:135], v11, s[28:31], s61 offen
    v_perm_b32 v176, v198, v194, s48
    v_perm_b32 v177, v206, v202, s48
    v_perm_b32 v178, v214, v210, s48
    v_perm_b32 v179, v222, v218, s48
    v_perm_b32 v180, v198, v194, s49
    v_perm_b32 v181, v206, v202, s49
    v_perm_b32 v182, v214, v210, s49
    s_mov_b32 s61, 2138112
    buffer_load_dwordx4 v[136:139], v11, s[28:31], s61 offen
    v_perm_b32 v183, v222, v218, s49
    v_mfma_f32_16x16x32_bf16 v[100:103], v[176:179], v[72:75], v[100:103]
    s_nop 0
    v_mfma_f32_16x16x32_bf16 v[104:107], v[180:183], v[72:75], v[104:107]
    s_mov_b32 s61, 2146304
    buffer_load_dwordx4 v[140:143], v11, s[28:31], s61 offen
    v_perm_b32 v184, v199, v195, s48
    v_perm_b32 v185, v207, v203, s48
    v_perm_b32 v186, v215, v211, s48
    v_perm_b32 v187, v223, v219, s48
    v_perm_b32 v188, v199, v195, s49
    v_perm_b32 v189, v207, v203, s49
    v_perm_b32 v190, v215, v211, s49
    s_mov_b32 s61, 2154496
    buffer_load_dwordx4 v[144:147], v11, s[28:31], s61 offen
    v_perm_b32 v191, v223, v219, s49
    v_mfma_f32_16x16x32_bf16 v[108:111], v[184:187], v[72:75], v[108:111]
    s_nop 0
    v_mfma_f32_16x16x32_bf16 v[112:115], v[188:191], v[72:75], v[112:115]
    s_add_u32 s61, s79, 0
    s_add_u32 m0, s53, 0
    s_nop 0
    buffer_load_dwordx4 v2, s[20:23], s61 offen offset:0 nt lds
    s_waitcnt vmcnt(9)
    s_waitcnt lgkmcnt(1)
    v_perm_b32 v176, v228, v224, s48
    v_perm_b32 v177, v236, v232, s48
    v_perm_b32 v178, v244, v240, s48
    v_perm_b32 v179, v252, v248, s48
    v_perm_b32 v180, v228, v224, s49
    v_perm_b32 v181, v236, v232, s49
    v_perm_b32 v182, v244, v240, s49
    buffer_load_dwordx4 v3, s[20:23], s61 offen offset:1024 nt lds
    v_perm_b32 v183, v252, v248, s49
    v_mfma_f32_16x16x32_bf16 v[84:87], v[176:179], v[76:79], v[84:87]
    s_nop 0
    v_mfma_f32_16x16x32_bf16 v[88:91], v[180:183], v[76:79], v[88:91]
    buffer_load_dwordx4 v4, s[20:23], s61 offen offset:2048 nt lds
    v_perm_b32 v184, v229, v225, s48
    v_perm_b32 v185, v237, v233, s48
    v_perm_b32 v186, v245, v241, s48
    v_perm_b32 v187, v253, v249, s48
    v_perm_b32 v188, v229, v225, s49
    v_perm_b32 v189, v237, v233, s49
    v_perm_b32 v190, v245, v241, s49
    buffer_load_dwordx4 v5, s[20:23], s61 offen offset:3072 nt lds
    v_perm_b32 v191, v253, v249, s49
    v_mfma_f32_16x16x32_bf16 v[92:95], v[184:187], v[76:79], v[92:95]
    s_nop 0
    v_mfma_f32_16x16x32_bf16 v[96:99], v[188:191], v[76:79], v[96:99]
    s_add_u32 s61, s79, 4096
    s_add_u32 m0, s53, 4096
    s_nop 0
    buffer_load_dwordx4 v2, s[20:23], s61 offen offset:0 nt lds
    v_perm_b32 v176, v230, v226, s48
    v_perm_b32 v177, v238, v234, s48
    v_perm_b32 v178, v246, v242, s48
    v_perm_b32 v179, v254, v250, s48
    v_perm_b32 v180, v230, v226, s49
    v_perm_b32 v181, v238, v234, s49
    v_perm_b32 v182, v246, v242, s49
    buffer_load_dwordx4 v3, s[20:23], s61 offen offset:1024 nt lds
    v_perm_b32 v183, v254, v250, s49
    v_mfma_f32_16x16x32_bf16 v[100:103], v[176:179], v[76:79], v[100:103]
    s_nop 0
    v_mfma_f32_16x16x32_bf16 v[104:107], v[180:183], v[76:79], v[104:107]
    buffer_load_dwordx4 v4, s[20:23], s61 offen offset:2048 nt lds
    v_perm_b32 v184, v231, v227, s48
    v_perm_b32 v185, v239, v235, s48
    v_perm_b32 v186, v247, v243, s48
    v_perm_b32 v187, v255, v251, s48
    v_perm_b32 v188, v231, v227, s49
    v_perm_b32 v189, v239, v235, s49
    v_perm_b32 v190, v247, v243, s49
    buffer_load_dwordx4 v5, s[20:23], s61 offen offset:3072 nt lds
    v_perm_b32 v191, v255, v251, s49
    v_mfma_f32_16x16x32_bf16 v[108:111], v[184:187], v[76:79], v[108:111]
    s_nop 0
    v_mfma_f32_16x16x32_bf16 v[112:115], v[188:191], v[76:79], v[112:115]
    s_waitcnt vmcnt(8)
    s_waitcnt lgkmcnt(0)
    v_perm_b32 v176, v120, v116, s48
    v_perm_b32 v177, v128, v124, s48
    v_perm_b32 v178, v136, v132, s48
    v_perm_b32 v179, v144, v140, s48
    v_perm_b32 v180, v120, v116, s49
    v_perm_b32 v181, v128, v124, s49
    v_perm_b32 v182, v136, v132, s49
    v_perm_b32 v183, v144, v140, s49
    v_mfma_f32_16x16x32_bf16 v[84:87], v[176:179], v[80:83], v[84:87]
    s_nop 0
    v_mfma_f32_16x16x32_bf16 v[88:91], v[180:183], v[80:83], v[88:91]
    v_perm_b32 v184, v121, v117, s48
    v_perm_b32 v185, v129, v125, s48
    v_perm_b32 v186, v137, v133, s48
    v_perm_b32 v187, v145, v141, s48
    v_perm_b32 v188, v121, v117, s49
    v_perm_b32 v189, v129, v125, s49
    v_perm_b32 v190, v137, v133, s49
    v_perm_b32 v191, v145, v141, s49
    v_mfma_f32_16x16x32_bf16 v[92:95], v[184:187], v[80:83], v[92:95]
    s_nop 0
    v_mfma_f32_16x16x32_bf16 v[96:99], v[188:191], v[80:83], v[96:99]
    v_perm_b32 v176, v122, v118, s48
    v_perm_b32 v177, v130, v126, s48
    v_perm_b32 v178, v138, v134, s48
    v_perm_b32 v179, v146, v142, s48
    v_perm_b32 v180, v122, v118, s49
    v_perm_b32 v181, v130, v126, s49
    v_perm_b32 v182, v138, v134, s49
    v_perm_b32 v183, v146, v142, s49
    v_mfma_f32_16x16x32_bf16 v[100:103], v[176:179], v[80:83], v[100:103]
    s_nop 0
    v_mfma_f32_16x16x32_bf16 v[104:107], v[180:183], v[80:83], v[104:107]
    v_perm_b32 v184, v123, v119, s48
    v_perm_b32 v185, v131, v127, s48
    v_perm_b32 v186, v139, v135, s48
    v_perm_b32 v187, v147, v143, s48
    v_perm_b32 v188, v123, v119, s49
    v_perm_b32 v189, v131, v127, s49
    v_perm_b32 v190, v139, v135, s49
    v_perm_b32 v191, v147, v143, s49
    v_mfma_f32_16x16x32_bf16 v[108:111], v[184:187], v[80:83], v[108:111]
    s_nop 0
    v_mfma_f32_16x16x32_bf16 v[112:115], v[188:191], v[80:83], v[112:115]
    s_waitcnt vmcnt(7)
    s_add_u32 s61, s79, 8192
    s_add_u32 m0, s55, 0
    s_nop 0
    buffer_load_dwordx4 v2, s[20:23], s61 offen offset:0 nt lds
    s_barrier
    s_lshl_b32 s83, s3, 13
    s_add_u32 s83, s83, 131072
    v_add_u32 v1, s83, v10
    ds_write_b128 v1, v[84:87] offset:0
    ds_write_b128 v1, v[88:91] offset:1024
    ds_write_b128 v1, v[92:95] offset:2048
    ds_write_b128 v1, v[96:99] offset:3072
    ds_write_b128 v1, v[100:103] offset:4096
    ds_write_b128 v1, v[104:107] offset:5120
    ds_write_b128 v1, v[108:111] offset:6144
    ds_write_b128 v1, v[112:115] offset:7168
    v_add_u32 v1, 131072, v10
    s_waitcnt lgkmcnt(0)
    s_barrier
    ds_read_b128 v[48:51], v1 offset:0
    ds_read_b128 v[52:55], v1 offset:16384
    ds_read_b128 v[56:59], v1 offset:1024
    ds_read_b128 v[60:63], v1 offset:17408
    s_waitcnt vmcnt(7)
    buffer_load_dwordx4 v3, s[20:23], s61 offen offset:1024 nt lds
    ds_read_b128 v[64:67], v1 offset:2048
    ds_read_b128 v[68:71], v1 offset:18432
    ds_read_b128 v[72:75], v1 offset:3072
    ds_read_b128 v[76:79], v1 offset:19456
    ds_read_b128 v[80:83], v1 offset:4096
    ds_read_b128 v[84:87], v1 offset:20480
    ds_read_b128 v[88:91], v1 offset:5120
    ds_read_b128 v[92:95], v1 offset:21504
    ds_read_b128 v[96:99], v1 offset:6144
    ds_read_b128 v[100:103], v1 offset:22528
    ds_read_b128 v[104:107], v1 offset:7168
    ds_read_b128 v[108:111], v1 offset:23552
    ds_read_b128 v[112:115], v1 offset:8192
    ds_read_b128 v[116:119], v1 offset:24576
    ds_read_b128 v[120:123], v1 offset:9216
    ds_read_b128 v[124:127], v1 offset:25600
    ds_read_b128 v[128:131], v1 offset:10240
    ds_read_b128 v[132:135], v1 offset:26624
    ds_read_b128 v[136:139], v1 offset:11264
    ds_read_b128 v[140:143], v1 offset:27648
    ds_read_b128 v[144:147], v1 offset:12288
    ds_read_b128 v[148:151], v1 offset:28672
    ds_read_b128 v[152:155], v1 offset:13312
    ds_read_b128 v[156:159], v1 offset:29696
    ds_read_b128 v[160:163], v1 offset:14336
    ds_read_b128 v[164:167], v1 offset:30720
    ds_read_b128 v[168:171], v1 offset:15360
    ds_read_b128 v[172:175], v1 offset:31744
    s_waitcnt lgkmcnt(15)
    v_add_f32 v48, v48, v52
    v_add_f32 v49, v49, v53
    v_add_f32 v50, v50, v54
    v_add_f32 v51, v51, v55
    v_add_f32 v56, v56, v60
    v_add_f32 v57, v57, v61
    v_add_f32 v58, v58, v62
    v_add_f32 v59, v59, v63
    s_waitcnt vmcnt(7)
    buffer_load_dwordx4 v4, s[20:23], s61 offen offset:2048 nt lds
    v_cvt_pk_bf16_f32 v16, v48, v56
    v_cvt_pk_bf16_f32 v20, v49, v57
    v_cvt_pk_bf16_f32 v24, v50, v58
    v_cvt_pk_bf16_f32 v28, v51, v59
    v_add_f32 v64, v64, v68
    v_add_f32 v65, v65, v69
    v_add_f32 v66, v66, v70
    v_add_f32 v67, v67, v71
    v_add_f32 v72, v72, v76
    v_add_f32 v73, v73, v77
    v_add_f32 v74, v74, v78
    v_add_f32 v75, v75, v79
    v_cvt_pk_bf16_f32 v17, v64, v72
    v_cvt_pk_bf16_f32 v21, v65, v73
    v_cvt_pk_bf16_f32 v25, v66, v74
    s_waitcnt vmcnt(7)
    buffer_load_dwordx4 v5, s[20:23], s61 offen offset:3072 nt lds
    v_cvt_pk_bf16_f32 v29, v67, v75
    v_add_f32 v80, v80, v84
    v_add_f32 v81, v81, v85
    v_add_f32 v82, v82, v86
    v_add_f32 v83, v83, v87
    v_add_f32 v88, v88, v92
    v_add_f32 v89, v89, v93
    v_add_f32 v90, v90, v94
    v_add_f32 v91, v91, v95
    v_cvt_pk_bf16_f32 v18, v80, v88
    v_cvt_pk_bf16_f32 v22, v81, v89
    v_cvt_pk_bf16_f32 v26, v82, v90
    v_cvt_pk_bf16_f32 v30, v83, v91
    v_add_f32 v96, v96, v100
    s_waitcnt vmcnt(7)
    s_add_u32 s61, s79, 12288
    s_add_u32 m0, s55, 4096
    s_nop 0
    buffer_load_dwordx4 v2, s[20:23], s61 offen offset:0 nt lds
    v_add_f32 v97, v97, v101
    v_add_f32 v98, v98, v102
    v_add_f32 v99, v99, v103
    v_add_f32 v104, v104, v108
    v_add_f32 v105, v105, v109
    v_add_f32 v106, v106, v110
    v_add_f32 v107, v107, v111
    v_cvt_pk_bf16_f32 v19, v96, v104
    v_cvt_pk_bf16_f32 v23, v97, v105
    v_cvt_pk_bf16_f32 v27, v98, v106
    v_cvt_pk_bf16_f32 v31, v99, v107
    s_waitcnt lgkmcnt(12)
    v_add_f32 v112, v112, v116
    v_add_f32 v113, v113, v117
    v_add_f32 v114, v114, v118
    v_add_f32 v115, v115, v119
    s_waitcnt vmcnt(7)
    buffer_load_dwordx4 v3, s[20:23], s61 offen offset:1024 nt lds
    v_add_f32 v120, v120, v124
    v_add_f32 v121, v121, v125
    v_add_f32 v122, v122, v126
    v_add_f32 v123, v123, v127
    v_cvt_pk_bf16_f32 v32, v112, v120
    v_cvt_pk_bf16_f32 v36, v113, v121
    v_cvt_pk_bf16_f32 v40, v114, v122
    v_cvt_pk_bf16_f32 v44, v115, v123
    s_waitcnt lgkmcnt(8)
    v_add_f32 v128, v128, v132
    v_add_f32 v129, v129, v133
    v_add_f32 v130, v130, v134
    v_add_f32 v131, v131, v135
    v_add_f32 v136, v136, v140
    v_add_f32 v137, v137, v141
    v_add_f32 v138, v138, v142
    s_waitcnt vmcnt(7)
    buffer_load_dwordx4 v4, s[20:23], s61 offen offset:2048 nt lds
    v_add_f32 v139, v139, v143
    v_cvt_pk_bf16_f32 v33, v128, v136
    v_cvt_pk_bf16_f32 v37, v129, v137
    v_cvt_pk_bf16_f32 v41, v130, v138
    v_cvt_pk_bf16_f32 v45, v131, v139
    s_waitcnt lgkmcnt(4)
    v_add_f32 v144, v144, v148
    v_add_f32 v145, v145, v149
    v_add_f32 v146, v146, v150
    v_add_f32 v147, v147, v151
    v_add_f32 v152, v152, v156
    v_add_f32 v153, v153, v157
    v_add_f32 v154, v154, v158
    v_add_f32 v155, v155, v159
    v_cvt_pk_bf16_f32 v34, v144, v152
    v_cvt_pk_bf16_f32 v38, v145, v153
    s_waitcnt vmcnt(7)
    buffer_load_dwordx4 v5, s[20:23], s61 offen offset:3072 nt lds
    v_cvt_pk_bf16_f32 v42, v146, v154
    v_cvt_pk_bf16_f32 v46, v147, v155
    s_waitcnt lgkmcnt(0)
    v_add_f32 v160, v160, v164
    v_add_f32 v161, v161, v165
    v_add_f32 v162, v162, v166
    v_add_f32 v163, v163, v167
    v_add_f32 v168, v168, v172
    v_add_f32 v169, v169, v173
    v_add_f32 v170, v170, v174
    v_add_f32 v171, v171, v175
    v_cvt_pk_bf16_f32 v35, v160, v168
    v_cvt_pk_bf16_f32 v39, v161, v169
    v_cvt_pk_bf16_f32 v43, v162, v170
    v_cvt_pk_bf16_f32 v47, v163, v171
    s_cmp_eq_u32 s64, 0
    s_nop 0
    s_cbranch_scc1 L_QB_ret0
    s_branch L_QB_ret1
L_OB:
    s_cmp_eq_u32 s3, 3
    s_cbranch_scc1 L_OB3
    s_add_u32 s61, s56, 0
    buffer_load_dwordx3 v[112:114], v13, s[32:35], s61 offen offset:0
    s_add_u32 s61, s56, 0
    buffer_load_dwordx3 v[116:118], v13, s[32:35], s61 offen offset:1152
    s_add_u32 s61, s56, 0
    buffer_load_dwordx3 v[120:122], v13, s[32:35], s61 offen offset:2304
    s_add_u32 s61, s56, 0
    buffer_load_dwordx3 v[124:126], v13, s[32:35], s61 offen offset:3456
    s_add_u32 s61, s56, 16384
    buffer_load_dwordx3 v[128:130], v13, s[32:35], s61 offen offset:2048
    s_add_u32 s61, s56, 16384
    buffer_load_dwordx3 v[132:134], v13, s[32:35], s61 offen offset:3200
    s_add_u32 s61, s56, 20480
    buffer_load_dwordx3 v[136:138], v13, s[32:35], s61 offen offset:256
    s_add_u32 s61, s56, 20480
    buffer_load_dwordx3 v[140:142], v13, s[32:35], s61 offen offset:1408
    s_add_u32 s61, s57, 0
    buffer_load_dwordx3 v[144:146], v13, s[32:35], s61 offen offset:0
    s_add_u32 s61, s57, 0
    buffer_load_dwordx3 v[148:150], v13, s[32:35], s61 offen offset:1152
    s_add_u32 s61, s57, 0
    buffer_load_dwordx3 v[152:154], v13, s[32:35], s61 offen offset:2304
    s_add_u32 s61, s57, 0
    buffer_load_dwordx3 v[156:158], v13, s[32:35], s61 offen offset:3456
    s_add_u32 s61, s57, 16384
    buffer_load_dwordx3 v[160:162], v13, s[32:35], s61 offen offset:2048
    s_add_u32 s61, s57, 16384
    buffer_load_dwordx3 v[164:166], v13, s[32:35], s61 offen offset:3200
    s_add_u32 s61, s57, 20480
    buffer_load_dwordx3 v[168:170], v13, s[32:35], s61 offen offset:256
    s_add_u32 s61, s57, 20480
    buffer_load_dwordx3 v[172:174], v13, s[32:35], s61 offen offset:1408
    s_waitcnt vmcnt(15)
    s_add_u32 s61, s58, 0
    buffer_load_dwordx3 v[16:18], v13, s[32:35], s61 offen offset:0
    s_waitcnt vmcnt(9)
    v_perm_b32 v176, v116, v112, s48
    v_perm_b32 v177, v124, v120, s48
    v_perm_b32 v178, v132, v128, s48
    v_perm_b32 v179, v140, v136, s48
    v_perm_b32 v180, v116, v112, s49
    v_perm_b32 v181, v124, v120, s49
    s_add_u32 s61, s58, 0
    buffer_load_dwordx3 v[20:22], v13, s[32:35], s61 offen offset:1152
    v_perm_b32 v182, v132, v128, s49
    v_perm_b32 v183, v140, v136, s49
    v_accvgpr_write_b32 a0, v176
    v_accvgpr_write_b32 a1, v177
    v_accvgpr_write_b32 a2, v178
    v_accvgpr_write_b32 a3, v179
    s_add_u32 s61, s58, 0
    buffer_load_dwordx3 v[24:26], v13, s[32:35], s61 offen offset:2304
    v_accvgpr_write_b32 a4, v180
    v_accvgpr_write_b32 a5, v181
    v_accvgpr_write_b32 a6, v182
    v_accvgpr_write_b32 a7, v183
    v_perm_b32 v184, v117, v113, s48
    v_perm_b32 v185, v125, v121, s48
    s_add_u32 s61, s58, 0
    buffer_load_dwordx3 v[28:30], v13, s[32:35], s61 offen offset:3456
    v_perm_b32 v186, v133, v129, s48
    v_perm_b32 v187, v141, v137, s48
    v_perm_b32 v188, v117, v113, s49
    v_perm_b32 v189, v125, v121, s49
    v_perm_b32 v190, v133, v129, s49
    v_perm_b32 v191, v141, v137, s49
    s_add_u32 s61, s58, 16384
    buffer_load_dwordx3 v[32:34], v13, s[32:35], s61 offen offset:2048
    v_accvgpr_write_b32 a8, v184
    v_accvgpr_write_b32 a9, v185
    v_accvgpr_write_b32 a10, v186
    v_accvgpr_write_b32 a11, v187
    v_accvgpr_write_b32 a12, v188
    v_accvgpr_write_b32 a13, v189
    s_add_u32 s61, s58, 16384
    buffer_load_dwordx3 v[36:38], v13, s[32:35], s61 offen offset:3200
    v_accvgpr_write_b32 a14, v190
    v_accvgpr_write_b32 a15, v191
    v_perm_b32 v176, v118, v114, s48
    v_perm_b32 v177, v126, v122, s48
    v_perm_b32 v178, v134, v130, s48
    v_perm_b32 v179, v142, v138, s48
    s_add_u32 s61, s58, 20480
    buffer_load_dwordx3 v[40:42], v13, s[32:35], s61 offen offset:256
    v_perm_b32 v180, v118, v114, s49
    v_perm_b32 v181, v126, v122, s49
    v_perm_b32 v182, v134, v130, s49
    v_perm_b32 v183, v142, v138, s49
    v_accvgpr_write_b32 a16, v176
    v_accvgpr_write_b32 a17, v177
    s_add_u32 s61, s58, 20480
    buffer_load_dwordx3 v[44:46], v13, s[32:35], s61 offen offset:1408
    v_accvgpr_write_b32 a18, v178
    v_accvgpr_write_b32 a19, v179
    v_accvgpr_write_b32 a20, v180
    v_accvgpr_write_b32 a21, v181
    v_accvgpr_write_b32 a22, v182
    v_accvgpr_write_b32 a23, v183
    s_waitcnt vmcnt(15)
    s_add_u32 s61, s59, 0
    buffer_load_dwordx3 v[112:114], v13, s[32:35], s61 offen offset:0
    s_waitcnt vmcnt(9)
    v_perm_b32 v176, v148, v144, s48
    v_perm_b32 v177, v156, v152, s48
    v_perm_b32 v178, v164, v160, s48
    v_perm_b32 v179, v172, v168, s48
    v_perm_b32 v180, v148, v144, s49
    v_perm_b32 v181, v156, v152, s49
    s_add_u32 s61, s59, 0
    buffer_load_dwordx3 v[116:118], v13, s[32:35], s61 offen offset:1152
    v_perm_b32 v182, v164, v160, s49
    v_perm_b32 v183, v172, v168, s49
    v_accvgpr_write_b32 a24, v176
    v_accvgpr_write_b32 a25, v177
    v_accvgpr_write_b32 a26, v178
    v_accvgpr_write_b32 a27, v179
    s_add_u32 s61, s59, 0
    buffer_load_dwordx3 v[120:122], v13, s[32:35], s61 offen offset:2304
    v_accvgpr_write_b32 a28, v180
    v_accvgpr_write_b32 a29, v181
    v_accvgpr_write_b32 a30, v182
    v_accvgpr_write_b32 a31, v183
    v_perm_b32 v184, v149, v145, s48
    v_perm_b32 v185, v157, v153, s48
    s_add_u32 s61, s59, 0
    buffer_load_dwordx3 v[124:126], v13, s[32:35], s61 offen offset:3456
    v_perm_b32 v186, v165, v161, s48
    v_perm_b32 v187, v173, v169, s48
    v_perm_b32 v188, v149, v145, s49
    v_perm_b32 v189, v157, v153, s49
    v_perm_b32 v190, v165, v161, s49
    v_perm_b32 v191, v173, v169, s49
    s_add_u32 s61, s59, 16384
    buffer_load_dwordx3 v[128:130], v13, s[32:35], s61 offen offset:2048
    v_accvgpr_write_b32 a32, v184
    v_accvgpr_write_b32 a33, v185
    v_accvgpr_write_b32 a34, v186
    v_accvgpr_write_b32 a35, v187
    v_accvgpr_write_b32 a36, v188
    v_accvgpr_write_b32 a37, v189
    s_add_u32 s61, s59, 16384
    buffer_load_dwordx3 v[132:134], v13, s[32:35], s61 offen offset:3200
    v_accvgpr_write_b32 a38, v190
    v_accvgpr_write_b32 a39, v191
    v_perm_b32 v176, v150, v146, s48
    v_perm_b32 v177, v158, v154, s48
    v_perm_b32 v178, v166, v162, s48
    v_perm_b32 v179, v174, v170, s48
    s_add_u32 s61, s59, 20480
    buffer_load_dwordx3 v[136:138], v13, s[32:35], s61 offen offset:256
    v_perm_b32 v180, v150, v146, s49
    v_perm_b32 v181, v158, v154, s49
    v_perm_b32 v182, v166, v162, s49
    v_perm_b32 v183, v174, v170, s49
    v_accvgpr_write_b32 a40, v176
    v_accvgpr_write_b32 a41, v177
    s_add_u32 s61, s59, 20480
    buffer_load_dwordx3 v[140:142], v13, s[32:35], s61 offen offset:1408
    v_accvgpr_write_b32 a42, v178
    v_accvgpr_write_b32 a43, v179
    v_accvgpr_write_b32 a44, v180
    v_accvgpr_write_b32 a45, v181
    v_accvgpr_write_b32 a46, v182
    v_accvgpr_write_b32 a47, v183
    s_waitcnt vmcnt(15)
    s_add_u32 s61, s56, 147456
    buffer_load_dwordx3 v[144:146], v13, s[32:35], s61 offen offset:0
    s_waitcnt vmcnt(9)
    v_perm_b32 v176, v20, v16, s48
    v_perm_b32 v177, v28, v24, s48
    v_perm_b32 v178, v36, v32, s48
    v_perm_b32 v179, v44, v40, s48
    v_perm_b32 v180, v20, v16, s49
    v_perm_b32 v181, v28, v24, s49
    s_add_u32 s61, s56, 147456
    buffer_load_dwordx3 v[148:150], v13, s[32:35], s61 offen offset:1152
    v_perm_b32 v182, v36, v32, s49
    v_perm_b32 v183, v44, v40, s49
    v_accvgpr_write_b32 a48, v176
    v_accvgpr_write_b32 a49, v177
    v_accvgpr_write_b32 a50, v178
    v_accvgpr_write_b32 a51, v179
    s_add_u32 s61, s56, 147456
    buffer_load_dwordx3 v[152:154], v13, s[32:35], s61 offen offset:2304
    v_accvgpr_write_b32 a52, v180
    v_accvgpr_write_b32 a53, v181
    v_accvgpr_write_b32 a54, v182
    v_accvgpr_write_b32 a55, v183
    v_perm_b32 v184, v21, v17, s48
    v_perm_b32 v185, v29, v25, s48
    s_add_u32 s61, s56, 147456
    buffer_load_dwordx3 v[156:158], v13, s[32:35], s61 offen offset:3456
    v_perm_b32 v186, v37, v33, s48
    v_perm_b32 v187, v45, v41, s48
    v_perm_b32 v188, v21, v17, s49
    v_perm_b32 v189, v29, v25, s49
    v_perm_b32 v190, v37, v33, s49
    v_perm_b32 v191, v45, v41, s49
    s_add_u32 s61, s56, 163840
    buffer_load_dwordx3 v[160:162], v13, s[32:35], s61 offen offset:2048
    v_accvgpr_write_b32 a56, v184
    v_accvgpr_write_b32 a57, v185
    v_accvgpr_write_b32 a58, v186
    v_accvgpr_write_b32 a59, v187
    v_accvgpr_write_b32 a60, v188
    v_accvgpr_write_b32 a61, v189
    s_add_u32 s61, s56, 163840
    buffer_load_dwordx3 v[164:166], v13, s[32:35], s61 offen offset:3200
    v_accvgpr_write_b32 a62, v190
    v_accvgpr_write_b32 a63, v191
    v_perm_b32 v176, v22, v18, s48
    v_perm_b32 v177, v30, v26, s48
    v_perm_b32 v178, v38, v34, s48
    v_perm_b32 v179, v46, v42, s48
    s_add_u32 s61, s56, 167936
    buffer_load_dwordx3 v[168:170], v13, s[32:35], s61 offen offset:256
    v_perm_b32 v180, v22, v18, s49
    v_perm_b32 v181, v30, v26, s49
    v_perm_b32 v182, v38, v34, s49
    v_perm_b32 v183, v46, v42, s49
    v_accvgpr_write_b32 a64, v176
    v_accvgpr_write_b32 a65, v177
    s_add_u32 s61, s56, 167936
    buffer_load_dwordx3 v[172:174], v13, s[32:35], s61 offen offset:1408
    v_accvgpr_write_b32 a66, v178
    v_accvgpr_write_b32 a67, v179
    v_accvgpr_write_b32 a68, v180
    v_accvgpr_write_b32 a69, v181
    v_accvgpr_write_b32 a70, v182
    v_accvgpr_write_b32 a71, v183
    s_waitcnt vmcnt(15)
    s_add_u32 s61, s57, 147456
    buffer_load_dwordx3 v[16:18], v13, s[32:35], s61 offen offset:0
    s_waitcnt vmcnt(9)
    v_perm_b32 v176, v116, v112, s48
    v_perm_b32 v177, v124, v120, s48
    v_perm_b32 v178, v132, v128, s48
    v_perm_b32 v179, v140, v136, s48
    v_perm_b32 v180, v116, v112, s49
    v_perm_b32 v181, v124, v120, s49
    s_add_u32 s61, s57, 147456
    buffer_load_dwordx3 v[20:22], v13, s[32:35], s61 offen offset:1152
    v_perm_b32 v182, v132, v128, s49
    v_perm_b32 v183, v140, v136, s49
    v_accvgpr_write_b32 a72, v176
    v_accvgpr_write_b32 a73, v177
    v_accvgpr_write_b32 a74, v178
    v_accvgpr_write_b32 a75, v179
    s_add_u32 s61, s57, 147456
    buffer_load_dwordx3 v[24:26], v13, s[32:35], s61 offen offset:2304
    v_accvgpr_write_b32 a76, v180
    v_accvgpr_write_b32 a77, v181
    v_accvgpr_write_b32 a78, v182
    v_accvgpr_write_b32 a79, v183
    v_perm_b32 v184, v117, v113, s48
    v_perm_b32 v185, v125, v121, s48
    s_add_u32 s61, s57, 147456
    buffer_load_dwordx3 v[28:30], v13, s[32:35], s61 offen offset:3456
    v_perm_b32 v186, v133, v129, s48
    v_perm_b32 v187, v141, v137, s48
    v_perm_b32 v188, v117, v113, s49
    v_perm_b32 v189, v125, v121, s49
    v_perm_b32 v190, v133, v129, s49
    v_perm_b32 v191, v141, v137, s49
    s_add_u32 s61, s57, 163840
    buffer_load_dwordx3 v[32:34], v13, s[32:35], s61 offen offset:2048
    v_accvgpr_write_b32 a80, v184
    v_accvgpr_write_b32 a81, v185
    v_accvgpr_write_b32 a82, v186
    v_accvgpr_write_b32 a83, v187
    v_accvgpr_write_b32 a84, v188
    v_accvgpr_write_b32 a85, v189
    s_add_u32 s61, s57, 163840
    buffer_load_dwordx3 v[36:38], v13, s[32:35], s61 offen offset:3200
    v_accvgpr_write_b32 a86, v190
    v_accvgpr_write_b32 a87, v191
    v_perm_b32 v176, v118, v114, s48
    v_perm_b32 v177, v126, v122, s48
    v_perm_b32 v178, v134, v130, s48
    v_perm_b32 v179, v142, v138, s48
    s_add_u32 s61, s57, 167936
    buffer_load_dwordx3 v[40:42], v13, s[32:35], s61 offen offset:256
    v_perm_b32 v180, v118, v114, s49
    v_perm_b32 v181, v126, v122, s49
    v_perm_b32 v182, v134, v130, s49
    v_perm_b32 v183, v142, v138, s49
    v_accvgpr_write_b32 a88, v176
    v_accvgpr_write_b32 a89, v177
    s_add_u32 s61, s57, 167936
    buffer_load_dwordx3 v[44:46], v13, s[32:35], s61 offen offset:1408
    v_accvgpr_write_b32 a90, v178
    v_accvgpr_write_b32 a91, v179
    v_accvgpr_write_b32 a92, v180
    v_accvgpr_write_b32 a93, v181
    v_accvgpr_write_b32 a94, v182
    v_accvgpr_write_b32 a95, v183
    s_waitcnt vmcnt(15)
    s_add_u32 s61, s58, 147456
    buffer_load_dwordx3 v[112:114], v13, s[32:35], s61 offen offset:0
    s_waitcnt vmcnt(9)
    v_perm_b32 v176, v148, v144, s48
    v_perm_b32 v177, v156, v152, s48
    v_perm_b32 v178, v164, v160, s48
    v_perm_b32 v179, v172, v168, s48
    v_perm_b32 v180, v148, v144, s49
    v_perm_b32 v181, v156, v152, s49
    s_add_u32 s61, s58, 147456
    buffer_load_dwordx3 v[116:118], v13, s[32:35], s61 offen offset:1152
    v_perm_b32 v182, v164, v160, s49
    v_perm_b32 v183, v172, v168, s49
    v_accvgpr_write_b32 a96, v176
    v_accvgpr_write_b32 a97, v177
    v_accvgpr_write_b32 a98, v178
    v_accvgpr_write_b32 a99, v179
    s_add_u32 s61, s58, 147456
    buffer_load_dwordx3 v[120:122], v13, s[32:35], s61 offen offset:2304
    v_accvgpr_write_b32 a100, v180
    v_accvgpr_write_b32 a101, v181
    v_accvgpr_write_b32 a102, v182
    v_accvgpr_write_b32 a103, v183
    v_perm_b32 v184, v149, v145, s48
    v_perm_b32 v185, v157, v153, s48
    s_add_u32 s61, s58, 147456
    buffer_load_dwordx3 v[124:126], v13, s[32:35], s61 offen offset:3456
    v_perm_b32 v186, v165, v161, s48
    v_perm_b32 v187, v173, v169, s48
    v_perm_b32 v188, v149, v145, s49
    v_perm_b32 v189, v157, v153, s49
    v_perm_b32 v190, v165, v161, s49
    v_perm_b32 v191, v173, v169, s49
    s_add_u32 s61, s58, 163840
    buffer_load_dwordx3 v[128:130], v13, s[32:35], s61 offen offset:2048
    v_accvgpr_write_b32 a104, v184
    v_accvgpr_write_b32 a105, v185
    v_accvgpr_write_b32 a106, v186
    v_accvgpr_write_b32 a107, v187
    v_accvgpr_write_b32 a108, v188
    v_accvgpr_write_b32 a109, v189
    s_add_u32 s61, s58, 163840
    buffer_load_dwordx3 v[132:134], v13, s[32:35], s61 offen offset:3200
    v_accvgpr_write_b32 a110, v190
    v_accvgpr_write_b32 a111, v191
    v_perm_b32 v176, v150, v146, s48
    v_perm_b32 v177, v158, v154, s48
    v_perm_b32 v178, v166, v162, s48
    v_perm_b32 v179, v174, v170, s48
    s_add_u32 s61, s58, 167936
    buffer_load_dwordx3 v[136:138], v13, s[32:35], s61 offen offset:256
    v_perm_b32 v180, v150, v146, s49
    v_perm_b32 v181, v158, v154, s49
    v_perm_b32 v182, v166, v162, s49
    v_perm_b32 v183, v174, v170, s49
    v_accvgpr_write_b32 a112, v176
    v_accvgpr_write_b32 a113, v177
    s_add_u32 s61, s58, 167936
    buffer_load_dwordx3 v[140:142], v13, s[32:35], s61 offen offset:1408
    v_accvgpr_write_b32 a114, v178
    v_accvgpr_write_b32 a115, v179
    v_accvgpr_write_b32 a116, v180
    v_accvgpr_write_b32 a117, v181
    v_accvgpr_write_b32 a118, v182
    v_accvgpr_write_b32 a119, v183
    s_waitcnt vmcnt(15)
    s_add_u32 s61, s59, 147456
    buffer_load_dwordx3 v[144:146], v13, s[32:35], s61 offen offset:0
    s_waitcnt vmcnt(9)
    v_perm_b32 v176, v20, v16, s48
    v_perm_b32 v177, v28, v24, s48
    v_perm_b32 v178, v36, v32, s48
    v_perm_b32 v179, v44, v40, s48
    v_perm_b32 v180, v20, v16, s49
    v_perm_b32 v181, v28, v24, s49
    s_add_u32 s61, s59, 147456
    buffer_load_dwordx3 v[148:150], v13, s[32:35], s61 offen offset:1152
    v_perm_b32 v182, v36, v32, s49
    v_perm_b32 v183, v44, v40, s49
    v_accvgpr_write_b32 a120, v176
    v_accvgpr_write_b32 a121, v177
    v_accvgpr_write_b32 a122, v178
    v_accvgpr_write_b32 a123, v179
    s_add_u32 s61, s59, 147456
    buffer_load_dwordx3 v[152:154], v13, s[32:35], s61 offen offset:2304
    v_accvgpr_write_b32 a124, v180
    v_accvgpr_write_b32 a125, v181
    v_accvgpr_write_b32 a126, v182
    v_accvgpr_write_b32 a127, v183
    v_perm_b32 v184, v21, v17, s48
    v_perm_b32 v185, v29, v25, s48
    s_add_u32 s61, s59, 147456
    buffer_load_dwordx3 v[156:158], v13, s[32:35], s61 offen offset:3456
    v_perm_b32 v186, v37, v33, s48
    v_perm_b32 v187, v45, v41, s48
    v_perm_b32 v188, v21, v17, s49
    v_perm_b32 v189, v29, v25, s49
    v_perm_b32 v190, v37, v33, s49
    v_perm_b32 v191, v45, v41, s49
    s_add_u32 s61, s59, 163840
    buffer_load_dwordx3 v[160:162], v13, s[32:35], s61 offen offset:2048
    v_accvgpr_write_b32 a128, v184
    v_accvgpr_write_b32 a129, v185
    v_accvgpr_write_b32 a130, v186
    v_accvgpr_write_b32 a131, v187
    v_accvgpr_write_b32 a132, v188
    v_accvgpr_write_b32 a133, v189
    s_add_u32 s61, s59, 163840
    buffer_load_dwordx3 v[164:166], v13, s[32:35], s61 offen offset:3200
    v_accvgpr_write_b32 a134, v190
    v_accvgpr_write_b32 a135, v191
    v_perm_b32 v176, v22, v18, s48
    v_perm_b32 v177, v30, v26, s48
    v_perm_b32 v178, v38, v34, s48
    v_perm_b32 v179, v46, v42, s48
    s_add_u32 s61, s59, 167936
    buffer_load_dwordx3 v[168:170], v13, s[32:35], s61 offen offset:256
    v_perm_b32 v180, v22, v18, s49
    v_perm_b32 v181, v30, v26, s49
    v_perm_b32 v182, v38, v34, s49
    v_perm_b32 v183, v46, v42, s49
    v_accvgpr_write_b32 a136, v176
    v_accvgpr_write_b32 a137, v177
    s_add_u32 s61, s59, 167936
    buffer_load_dwordx3 v[172:174], v13, s[32:35], s61 offen offset:1408
    v_accvgpr_write_b32 a138, v178
    v_accvgpr_write_b32 a139, v179
    v_accvgpr_write_b32 a140, v180
    v_accvgpr_write_b32 a141, v181
    v_accvgpr_write_b32 a142, v182
    v_accvgpr_write_b32 a143, v183
    s_add_u32 s61, s79, 0
    s_add_u32 m0, s53, 0
    s_nop 0
    buffer_load_dwordx4 v2, s[24:27], s61 offen offset:0 nt lds
    s_waitcnt vmcnt(9)
    v_perm_b32 v176, v116, v112, s48
    v_perm_b32 v177, v124, v120, s48
    v_perm_b32 v178, v132, v128, s48
    v_perm_b32 v179, v140, v136, s48
    v_perm_b32 v180, v116, v112, s49
    v_perm_b32 v181, v124, v120, s49
    buffer_load_dwordx4 v3, s[24:27], s61 offen offset:1024 nt lds
    v_perm_b32 v182, v132, v128, s49
    v_perm_b32 v183, v140, v136, s49
    v_accvgpr_write_b32 a144, v176
    v_accvgpr_write_b32 a145, v177
    v_accvgpr_write_b32 a146, v178
    v_accvgpr_write_b32 a147, v179
    buffer_load_dwordx4 v2, s[24:27], s61 offen offset:2048 nt lds
    v_accvgpr_write_b32 a148, v180
    v_accvgpr_write_b32 a149, v181
    v_accvgpr_write_b32 a150, v182
    v_accvgpr_write_b32 a151, v183
    v_perm_b32 v184, v117, v113, s48
    v_perm_b32 v185, v125, v121, s48
    buffer_load_dwordx4 v3, s[24:27], s61 offen offset:3072 nt lds
    v_perm_b32 v186, v133, v129, s48
    v_perm_b32 v187, v141, v137, s48
    v_perm_b32 v188, v117, v113, s49
    v_perm_b32 v189, v125, v121, s49
    v_perm_b32 v190, v133, v129, s49
    v_perm_b32 v191, v141, v137, s49
    s_add_u32 s61, s79, 4096
    s_add_u32 m0, s53, 4096
    s_nop 0
    buffer_load_dwordx4 v2, s[24:27], s61 offen offset:0 nt lds
    v_accvgpr_write_b32 a152, v184
    v_accvgpr_write_b32 a153, v185
    v_accvgpr_write_b32 a154, v186
    v_accvgpr_write_b32 a155, v187
    v_accvgpr_write_b32 a156, v188
    v_accvgpr_write_b32 a157, v189
    buffer_load_dwordx4 v3, s[24:27], s61 offen offset:1024 nt lds
    v_accvgpr_write_b32 a158, v190
    v_accvgpr_write_b32 a159, v191
    v_perm_b32 v176, v118, v114, s48
    v_perm_b32 v177, v126, v122, s48
    v_perm_b32 v178, v134, v130, s48
    v_perm_b32 v179, v142, v138, s48
    buffer_load_dwordx4 v2, s[24:27], s61 offen offset:2048 nt lds
    v_perm_b32 v180, v118, v114, s49
    v_perm_b32 v181, v126, v122, s49
    v_perm_b32 v182, v134, v130, s49
    v_perm_b32 v183, v142, v138, s49
    v_accvgpr_write_b32 a160, v176
    v_accvgpr_write_b32 a161, v177
    buffer_load_dwordx4 v3, s[24:27], s61 offen offset:3072 nt lds
    v_accvgpr_write_b32 a162, v178
    v_accvgpr_write_b32 a163, v179
    v_accvgpr_write_b32 a164, v180
    v_accvgpr_write_b32 a165, v181
    v_accvgpr_write_b32 a166, v182
    v_accvgpr_write_b32 a167, v183
    s_waitcnt vmcnt(8)
    v_perm_b32 v176, v148, v144, s48
    v_perm_b32 v177, v156, v152, s48
    v_perm_b32 v178, v164, v160, s48
    v_perm_b32 v179, v172, v168, s48
    v_perm_b32 v180, v148, v144, s49
    v_perm_b32 v181, v156, v152, s49
    v_perm_b32 v182, v164, v160, s49
    v_perm_b32 v183, v172, v168, s49
    v_accvgpr_write_b32 a168, v176
    v_accvgpr_write_b32 a169, v177
    v_accvgpr_write_b32 a170, v178
    v_accvgpr_write_b32 a171, v179
    v_accvgpr_write_b32 a172, v180
    v_accvgpr_write_b32 a173, v181
    v_accvgpr_write_b32 a174, v182
    v_accvgpr_write_b32 a175, v183
    v_perm_b32 v184, v149, v145, s48
    v_perm_b32 v185, v157, v153, s48
    v_perm_b32 v186, v165, v161, s48
    v_perm_b32 v187, v173, v169, s48
    v_perm_b32 v188, v149, v145, s49
    v_perm_b32 v189, v157, v153, s49
    v_perm_b32 v190, v165, v161, s49
    v_perm_b32 v191, v173, v169, s49
    v_accvgpr_write_b32 a176, v184
    v_accvgpr_write_b32 a177, v185
    v_accvgpr_write_b32 a178, v186
    v_accvgpr_write_b32 a179, v187
    v_accvgpr_write_b32 a180, v188
    v_accvgpr_write_b32 a181, v189
    v_accvgpr_write_b32 a182, v190
    v_accvgpr_write_b32 a183, v191
    v_perm_b32 v176, v150, v146, s48
    v_perm_b32 v177, v158, v154, s48
    v_perm_b32 v178, v166, v162, s48
    v_perm_b32 v179, v174, v170, s48
    v_perm_b32 v180, v150, v146, s49
    v_perm_b32 v181, v158, v154, s49
    v_perm_b32 v182, v166, v162, s49
    v_perm_b32 v183, v174, v170, s49
    v_accvgpr_write_b32 a184, v176
    v_accvgpr_write_b32 a185, v177
    v_accvgpr_write_b32 a186, v178
    v_accvgpr_write_b32 a187, v179
    v_accvgpr_write_b32 a188, v180
    v_accvgpr_write_b32 a189, v181
    v_accvgpr_write_b32 a190, v182
    v_accvgpr_write_b32 a191, v183
    s_cmp_eq_u32 s64, 0
    s_nop 0
    s_cbranch_scc1 L_OB_ret0
    s_branch L_OB_ret1
L_OB3:
    s_add_u32 s61, s79, 0
    s_add_u32 m0, s53, 0
    s_nop 0
    buffer_load_dwordx4 v2, s[24:27], s61 offen offset:0 nt lds
    buffer_load_dwordx4 v3, s[24:27], s61 offen offset:1024 nt lds
    buffer_load_dwordx4 v2, s[24:27], s61 offen offset:2048 nt lds
    buffer_load_dwordx4 v3, s[24:27], s61 offen offset:3072 nt lds
    s_add_u32 s61, s79, 4096
    s_add_u32 m0, s53, 4096
    s_nop 0
    buffer_load_dwordx4 v2, s[24:27], s61 offen offset:0 nt lds
    buffer_load_dwordx4 v3, s[24:27], s61 offen offset:1024 nt lds
    buffer_load_dwordx4 v2, s[24:27], s61 offen offset:2048 nt lds
    buffer_load_dwordx4 v3, s[24:27], s61 offen offset:3072 nt lds
    s_cmp_eq_u32 s64, 0
    s_cbranch_scc1 L_OB_ret0
    s_branch L_OB_ret1
L_statpoll:
    s_mov_b32 s82, 2000000
L_statloop:
    buffer_load_dwordx4 v[72:75], v1, s[40:43], s54 offen offset:0 sc1
    buffer_load_dwordx4 v[76:79], v1, s[40:43], s54 offen offset:256 sc1
    s_waitcnt vmcnt(0)
    v_xor_b32 v80, s66, v74
    v_xor_b32 v81, s66, v75
    v_xor_b32 v82, s66, v78
    v_xor_b32 v83, s66, v79
    v_or_b32 v84, v81, v83
    v_and_b32 v84, 0x0fffffff, v84
    v_or3_b32 v80, v80, v84, v82
    v_cmp_eq_u32 vcc, 0, v80
    s_nop 0
    s_cmp_eq_u64 vcc, -1
    s_nop 2
    s_cbranch_scc1 L_statok
    s_sub_u32 s82, s82, 1
    s_cmp_lg_u32 s82, 0
    s_cbranch_scc1 L_statloop
    s_endpgm
L_codeend:
    s_nop 0
    s_nop 0
    s_nop 0
    s_nop 0
    s_nop 0
    s_nop 0
    s_nop 0
    s_nop 0
    s_nop 0
    s_nop 0
    s_nop 0
    s_nop 0
    s_nop 0
    s_nop 0
    s_nop 0
    s_nop 0
    s_nop 0
    s_nop 0
    s_nop 0
    s_nop 0
    s_nop 0
    s_nop 0
    s_nop 0
    s_nop 0
    s_nop 0
    s_nop 0
    s_nop 0
    s_nop 0
    s_nop 0
    s_nop 0
    s_nop 0
    s_nop 0
    s_nop 0
    s_nop 0
    s_nop 0
    s_nop 0
    s_nop 0
    s_nop 0
    s_nop 0
    s_nop 0
    s_nop 0
    s_nop 0
    s_nop 0
    s_nop 0
    s_nop 0
    s_nop 0
    s_nop 0
    s_nop 0
    s_nop 0
    s_nop 0
    s_nop 0
    s_nop 0
    s_nop 0
    s_nop 0
    s_nop 0
    s_nop 0
    s_nop 0
    s_nop 0
    s_nop 0
    s_nop 0
    s_nop 0
    s_nop 0
    s_nop 0
    s_nop 0
.section .rodata,"a"
.p2align 6
.amdhsa_kernel standalone__sliding_block_cached__sampling_kernel
  .amdhsa_next_free_vgpr 512
  .amdhsa_next_free_sgpr 102
  .amdhsa_accum_offset 256
  .amdhsa_group_segment_fixed_size 0
  .amdhsa_kernarg_size 64
  .amdhsa_user_sgpr_count 2
  .amdhsa_user_sgpr_kernarg_segment_ptr 1
  .amdhsa_system_sgpr_workgroup_id_x 1
.end_amdhsa_kernel
```
